```python
import torch

def _softmax(x, axis=-1):
    return torch.softmax(x, dim=axis)
def _gelu(x):
    return torch.nn.functional.gelu(x, approximate="tanh")
def _silu(x):
    return torch.nn.functional.silu(x)
def _sigmoid(x):
    return torch.sigmoid(x)
def _layernorm(x, axis=-1, eps=1e-5):
    m = x.mean(dim=axis, keepdim=True)
    v = x.var(dim=axis, keepdim=True, unbiased=False)
    return (x - m) / torch.sqrt(v + eps)
def _scatter_add(tgt, idx, src, axis=0):
    return tgt.clone().index_add_(axis, idx, src)
def _segment_sum(src, seg, n):
    out = torch.zeros((n,) + src.shape[1:], dtype=src.dtype)
    return out.index_add_(0, seg, src)
def _pad(x, pw):
    flat = tuple(v for pair in reversed(pw) for v in pair)
    return torch.nn.functional.pad(x, flat)

kernel_name = 'gated_mix__linear_attn_block__dense_activation_silu__prompt'

def setup_inputs():

    _w = (lambda a: (lambda t: t.to(torch.bfloat16) if t.is_floating_point() else t)(torch.as_tensor(a)))
    def _A_setup():
        B, S, D = 1, 2048, 512
        return {
            "x": _w((lambda *s: torch.randn(*s, dtype=torch.bfloat16) * 0.1)(B, S, D)),
            "wqkv": _w((lambda *s: torch.randn(*s, dtype=torch.bfloat16) * 0.8)(D, 3 * D)),
            "wo": _w((lambda *s: torch.randn(*s, dtype=torch.bfloat16) * 0.4)(D, D)),
        }
    _A_in = _A_setup()

    def _B_setup():
        B, S, D, F = 1, 2048, 512, 1792
        return {
            "x": _w((lambda *s: torch.randn(*s, dtype=torch.bfloat16) * 0.1)(B, S, D)),
            "w1": _w((lambda *s: torch.randn(*s, dtype=torch.bfloat16) * 3.2)(D, F) * (D ** -0.5)),
            "w2": _w((lambda *s: torch.randn(*s, dtype=torch.bfloat16) * 3.2)(F, D) * (F ** -0.5)),
        }
    _B_in = _B_setup()

    return {
        "A_x": _A_in["x"],
        "A_wqkv": _A_in["wqkv"],
        "A_wo": _A_in["wo"],
        "B_x": _B_in["x"],
        "B_w1": _B_in["w1"],
        "B_w2": _B_in["w2"],
        "gate_w": _w((lambda *s: torch.randn(*s, dtype=torch.bfloat16) * 0.1)(512) * 16.0),
    }

def reference(A_x, A_wqkv, A_wo, B_x, B_w1, B_w2, gate_w):
    def _A_ref(x, wqkv, wo):
        B, S, D = x.shape
        H = 32; Dh = D // H
        qkv = (lambda x, *d: x.permute(*d))((x @ wqkv).reshape(B, S, 3, H, Dh), 2, 0, 3, 1, 4)
        q, k, v = qkv[0], qkv[1], qkv[2]
        phi = lambda t: torch.where(t > 0, t + 1, torch.exp(t)) + 1e-6
        pq, pk = phi(q), phi(k)
        kv = torch.einsum("bhsd,bhse->bhde", pk, v)
        z = torch.einsum("bhsd->bhd", pk)
        num = torch.einsum("bhqd,bhde->bhqe", pq, kv)
        den = torch.einsum("bhqd,bhd->bhq", pq, z)[..., None] + 1e-6
        o = num / den
        return (lambda x, *d: x.permute(*d))(o, 0, 2, 1, 3).reshape(B, S, D) @ wo

    def _B_ref(x, w1, w2):
        h = torch.einsum("bsd,df->bsf", x, w1)
        h = _silu(h)
        out = torch.einsum("bsf,fd->bsd", h, w2)
        return out

    x = A_x
    g = _sigmoid((x * gate_w).sum(-1, keepdims=True))
    a = _A_ref(x, A_wqkv, A_wo)
    b = _B_ref(x, B_w1, B_w2)
    return g * a + (1 - g) * b
```

```asm
; @launch grid=(256,1,1) block=(256,1,1) lds=163840
.amdgcn_target "amdgcn-amd-amdhsa--gfx950"
.text
.globl gated_mix__linear_attn_block__dense_activation_silu__prompt_kernel
.p2align 8
.type gated_mix__linear_attn_block__dense_activation_silu__prompt_kernel,@function
gated_mix__linear_attn_block__dense_activation_silu__prompt_kernel:
    s_cmp_ge_u32 s2, 256
    s_cbranch_scc1 L_end
    s_load_dwordx2 s[8:9], s[0:1], 0
    s_load_dwordx2 s[16:17], s[0:1], 40
    s_load_dwordx2 s[20:21], s[0:1], 16
    s_load_dwordx2 s[24:25], s[0:1], 72
    s_load_dwordx2 s[28:29], s[0:1], 56
    s_load_dwordx2 s[32:33], s[0:1], 48
    s_load_dwordx2 s[36:37], s[0:1], 64
    s_memrealtime s[4:5]
    v_lshrrev_b32 v248, 6, v0
    v_and_b32 v241, 63, v0
    s_and_b32 s55, s2, 7
    v_readfirstlane_b32 s40, v248
    s_lshr_b32 s56, s2, 3
    s_and_b32 s51, s55, 1
    s_lshl_b32 s51, s51, 3
    s_add_u32 s50, s56, 0
    s_and_b32 s50, s50, 7
    s_add_u32 s41, s50, s51
    s_add_u32 s50, s56, 0
    s_and_b32 s50, s50, 7
    s_lshr_b32 s49, s56, 3
    s_and_b32 s42, s55, 6
    s_and_b32 s51, s49, 1
    s_add_u32 s42, s42, s51
    s_lshl_b32 s46, s40, 13
    s_add_u32 s43, s41, s42
    s_mov_b32 s10, 0x200000
    s_mov_b32 s11, 0x20000
    v_lshrrev_b32 v248, 3, v241
    v_lshrrev_b32 v249, 4, v241
    v_and_b32 v250, 7, v241
    v_xor_b32 v252, v249, v250
    s_lshl_b32 s51, s41, 17
    s_lshl_b32 s60, s40, 15
    s_add_u32 s51, s51, s60
    v_lshlrev_b32 v253, 10, v248
    v_lshl_add_u32 v252, v252, 4, v253
    v_add_u32 v225, s51, v252
    v_xor_b32 v252, 64, v225
    v_add_u32 v226, 7168, v252
    v_add_u32 v227, 14336, v225
    v_add_u32 v228, 21504, v252
    v_and_b32 v249, 1, v249
    v_lshlrev_b32 v249, 2, v249
    v_xor_b32 v249, v249, v250
    v_lshlrev_b32 v249, 4, v249
    s_cmp_ge_u32 s49, 2
    s_cbranch_scc1 L_A
    s_load_dwordx2 s[12:13], s[0:1], 32
    s_mov_b32 s14, 0x1c0000
    s_mov_b32 s15, 0x20000
    s_add_u32 s43, s43, 4
    s_mul_i32 s52, s42, 448
    s_bitcmp1_b32 s42, 0
    s_cselect_b32 s57, 192, 0
    s_cselect_b32 s59, 64, 256
    s_cselect_b32 s62, 0, 384
    s_add_u32 s57, s57, s52
    s_add_u32 s59, s59, s52
    s_add_u32 s62, s62, s52
    s_and_b32 s43, s43, 3
    s_mul_i32 s51, s40, 57344
    s_add_u32 s52, s51, s57
    v_mul_u32_u24 v252, 3584, v248
    v_add3_u32 v229, v252, v249, s52
    v_add_u32 v230, 27648, v229
    v_add_u32 v231, 128, v229
    v_add_u32 v232, 27776, v229
    s_waitcnt lgkmcnt(0)
    s_add_u32 m0, s46, 4096
    s_lshl_b32 s44, s43, 7
    s_mul_i32 s45, s43, 229376
    buffer_load_dwordx4 v229, s[12:15], s45 offen lds
    buffer_load_dwordx4 v230, s[12:15], s45 offen offset:1024 lds
    s_add_u32 m0, s46, 6144
    s_nop 0
    buffer_load_dwordx4 v231, s[12:15], s45 offen lds
    buffer_load_dwordx4 v232, s[12:15], s45 offen offset:1024 lds
    s_add_u32 m0, s46, 0
    s_nop 0
    buffer_load_dwordx4 v225, s[8:11], s44 offen lds
    buffer_load_dwordx4 v226, s[8:11], s44 offen offset:1024 lds
    buffer_load_dwordx4 v227, s[8:11], s44 offen offset:2048 lds
    buffer_load_dwordx4 v228, s[8:11], s44 offen offset:3072 lds
    s_add_u32 m0, s46, 36864
    s_add_u32 s43, s43, 1
    s_and_b32 s43, s43, 7
    s_lshl_b32 s44, s43, 7
    s_mul_i32 s45, s43, 229376
    buffer_load_dwordx4 v229, s[12:15], s45 offen lds
    buffer_load_dwordx4 v230, s[12:15], s45 offen offset:1024 lds
    s_add_u32 m0, s46, 38912
    s_nop 0
    buffer_load_dwordx4 v231, s[12:15], s45 offen lds
    buffer_load_dwordx4 v232, s[12:15], s45 offen offset:1024 lds
    s_add_u32 m0, s46, 32768
    s_nop 0
    buffer_load_dwordx4 v225, s[8:11], s44 offen lds
    buffer_load_dwordx4 v226, s[8:11], s44 offen offset:1024 lds
    buffer_load_dwordx4 v227, s[8:11], s44 offen offset:2048 lds
    buffer_load_dwordx4 v228, s[8:11], s44 offen offset:3072 lds
    s_mov_b32 s26, 0x10000000
    s_mov_b32 s27, 0x20000
    s_mov_b32 s18, 0x1c0000
    s_mov_b32 s19, 0x20000
    s_mov_b32 s22, 0x80000
    s_mov_b32 s23, 0x20000
    s_mov_b32 s30, 0x200000
    s_mov_b32 s31, 0x20000
    s_mov_b32 s38, 0x100
    s_mov_b32 s39, 0x20000
    s_mov_b32 s54, 0xbfb8aa3b
    s_mul_i32 s51, s40, 57344
    s_add_u32 s52, s51, s59
    v_mul_u32_u24 v252, 3584, v248
    v_add3_u32 v208, v252, v249, s52
    v_add_u32 v209, 27648, v208
    v_lshrrev_b32 v252, 2, v241
    v_mul_u32_u24 v252, 3584, v252
    v_and_b32 v253, 3, v241
    v_lshlrev_b32 v253, 4, v253
    s_add_u32 s52, s51, s62
    v_add3_u32 v210, v252, v253, s52
    s_lshl_b32 s57, s57, 5
    s_add_u32 s58, s57, 4096
    s_lshl_b32 s59, s59, 5
    s_lshl_b32 s62, s62, 5
    s_mul_i32 s52, s40, 28672
    s_lshl_b32 s48, s40, 13
    s_add_u32 s51, s49, 0
    s_and_b32 s51, s51, 3
    s_lshl_b32 s64, s51, 12
    s_add_u32 s64, s64, s52
    s_cmp_ge_u32 s51, 2
    s_cselect_b32 s60, 12288, 0
    s_add_u32 s64, s64, s60
    s_mul_i32 s68, s51, 3072
    s_add_u32 s68, s68, s52
    s_add_u32 s68, s68, 8192
    s_lshl_b32 s72, s51, 11
    s_add_u32 s72, s72, s48
    s_add_u32 s51, s49, 1
    s_and_b32 s51, s51, 3
    s_lshl_b32 s65, s51, 12
    s_add_u32 s65, s65, s52
    s_cmp_ge_u32 s51, 2
    s_cselect_b32 s60, 12288, 0
    s_add_u32 s65, s65, s60
    s_mul_i32 s69, s51, 3072
    s_add_u32 s69, s69, s52
    s_add_u32 s69, s69, 8192
    s_lshl_b32 s73, s51, 11
    s_add_u32 s73, s73, s48
    s_add_u32 s51, s49, 2
    s_and_b32 s51, s51, 3
    s_lshl_b32 s66, s51, 12
    s_add_u32 s66, s66, s52
    s_cmp_ge_u32 s51, 2
    s_cselect_b32 s60, 12288, 0
    s_add_u32 s66, s66, s60
    s_mul_i32 s70, s51, 3072
    s_add_u32 s70, s70, s52
    s_add_u32 s70, s70, 8192
    s_lshl_b32 s74, s51, 11
    s_add_u32 s74, s74, s48
    s_add_u32 s51, s49, 3
    s_and_b32 s51, s51, 3
    s_lshl_b32 s67, s51, 12
    s_add_u32 s67, s67, s52
    s_cmp_ge_u32 s51, 2
    s_cselect_b32 s60, 12288, 0
    s_add_u32 s67, s67, s60
    s_mul_i32 s71, s51, 3072
    s_add_u32 s71, s71, s52
    s_add_u32 s71, s71, 8192
    s_lshl_b32 s75, s51, 11
    s_add_u32 s75, s75, s48
    s_lshl2_add_u32 s49, s55, s49
    s_mul_i32 s86, s49, 229376
    s_lshl_b32 s96, s49, 16
    s_add_u32 s87, s96, 8388608
    s_add_u32 s96, s96, s46
    s_lshl_b32 s51, s50, 7
    s_add_u32 s96, s96, s51
    s_add_u32 s97, s96, 32768
    s_lshl_b32 s88, s49, 11
    s_add_u32 s88, s88, 11599872
    s_lshl_b32 s89, s49, 9
    s_add_u32 s89, s89, 12582912
    s_lshl_b32 s90, s55, 11
    s_lshl_b32 s52, s40, 9
    s_add_u32 s90, s90, s52
    s_add_u32 s90, s90, 12615680
    s_lshl_b32 s52, s40, 1
    s_lshl_b32 s76, 3, s52
    s_mov_b32 s77, s76
    s_lshl_b32 s78, s76, 8
    s_mov_b32 s79, s78
    s_mov_b32 s80, 0xff0000
    s_mov_b32 s81, 0xff0000
    s_or_b64 s[82:83], s[78:79], s[80:81]
    s_or_b64 s[100:101], s[76:77], s[80:81]
    v_lshlrev_b32 v242, 4, v241
    v_lshl_add_u32 v252, v248, 10, v249
    v_add_u32 v233, s51, v252
    v_add_u32 v234, 7168, v233
    v_and_b32 v252, 31, v241
    v_lshrrev_b32 v253, 5, v241
    v_bfe_u32 v254, v241, 1, 3
    v_xor_b32 v254, v253, v254
    v_lshlrev_b32 v254, 4, v254
    v_lshl_add_u32 v254, v252, 7, v254
    v_xor_b32 v255, 0, v254
    v_add_u32 v211, s46, v255
    v_add_u32 v215, 65536, v211
    v_xor_b32 v255, 32, v254
    v_add_u32 v212, s46, v255
    v_add_u32 v216, 65536, v212
    v_xor_b32 v255, 64, v254
    v_add_u32 v213, s46, v255
    v_add_u32 v217, 65536, v213
    v_xor_b32 v255, 96, v254
    v_add_u32 v214, s46, v255
    v_add_u32 v218, 65536, v214
    v_bfe_u32 v252, v241, 2, 2
    v_bfe_u32 v254, v241, 4, 1
    v_lshlrev_b32 v254, 1, v254
    v_bfe_u32 v255, v241, 1, 1
    v_or_b32 v254, v254, v255
    v_bfe_u32 v255, v241, 3, 1
    v_lshl_or_b32 v254, v255, 2, v254
    v_and_b32 v255, 1, v241
    v_lshlrev_b32 v255, 3, v255
    v_lshl_or_b32 v254, v254, 4, v255
    v_lshl_add_u32 v254, v252, 7, v254
    v_lshl_add_u32 v219, v253, 10, v254
    v_xor_b32 v220, 64, v219
    v_add_u32 v221, 65536, v219
    v_add_u32 v222, 65536, v220
    v_lshl_add_u32 v255, v253, 9, v254
    v_add_u32 v235, s46, v255
    v_xor_b32 v236, 64, v235
    v_add_u32 v237, 65536, v235
    v_add_u32 v238, 65536, v236
    v_add_u32 v239, 131072, v235
    v_add_u32 v240, 131072, v236
    s_lshl2_add_u32 s51, s41, s40
    s_lshl_b32 s52, s51, 8
    s_lshl2_add_u32 s52, s42, s52
    s_add_u32 s52, s52, 12582912
    v_mov_b32 v245, s52
    v_lshl_add_u32 v255, v253, 3, v252
    v_lshlrev_b32 v255, 6, v255
    v_bfe_u32 v254, v241, 4, 1
    v_lshl_add_u32 v255, v254, 5, v255
    v_and_b32 v254, 3, v241
    v_lshl_add_u32 v223, v254, 3, v255
    v_add_u32 v224, 65536, v223
    s_mul_i32 s51, s51, 114688
    v_add_u32 v244, s51, v242
    s_or_b32 s51, s2, s40
    s_cmp_lg_u32 s51, 0
    s_cbranch_scc1 L_np
    s_or_b32 s51, s4, 1
    v_mov_b32 v252, s51
    v_mov_b32 v253, 0
    buffer_store_dword v252, v253, s[36:39], 0 offen sc1
L_np:
    s_lshl2_add_u32 s3, s2, s40
    v_lshlrev_b32 v67, 7, v241
    v_and_b32 v68, 0x7ff, v67
    v_and_b32 v69, 0x1ff, v67
    v_and_b32 v67, 0xfff, v67
    s_mul_i32 s99, s3, 1792
    s_lshl_b32 s51, s3, 9
    s_lshl_b32 s52, s3, 11
    s_and_b32 s3, s3, 511
    s_mul_i32 s3, s3, 3584
    buffer_load_dword v65, v68, s[16:19], s99 offen
    buffer_load_dword v65, v69, s[20:23], s51 offen
    v_and_b32 v64, 15, v241
    v_lshlrev_b32 v64, 10, v64
    v_and_b32 v66, 16, v241
    v_lshl_add_u32 v64, v66, 2, v64
    v_and_b32 v66, 0xc40, v64
    s_lshl2_add_u32 s3, s56, s40
    s_mul_i32 s99, s3, 14336
    s_lshl_b32 s3, s3, 12
    s_lshr_b32 s51, s16, 7
    s_sub_u32 s51, 3, s51
    s_and_b32 s51, s51, 7
    s_lshl_b32 s51, s51, 7
    s_add_u32 s99, s99, s51
    s_lshr_b32 s51, s20, 7
    s_sub_u32 s51, 3, s51
    s_and_b32 s51, s51, 7
    s_lshl_b32 s51, s51, 7
    s_add_u32 s3, s3, s51
    s_waitcnt vmcnt(10)
    s_barrier
    ds_read_b128 a[128:131], v211 offset:0
    ds_read_b64_tr_b16 v[112:113], v219 offset:4096
    ds_read_b64_tr_b16 v[114:115], v219 offset:4608
    ds_read_b64_tr_b16 v[116:117], v220 offset:4096
    ds_read_b64_tr_b16 v[118:119], v220 offset:4608
    ds_read_b64_tr_b16 v[120:121], v219 offset:6144
    ds_read_b64_tr_b16 v[122:123], v219 offset:6656
    ds_read_b64_tr_b16 v[124:125], v220 offset:6144
    ds_read_b64_tr_b16 v[126:127], v220 offset:6656
    ds_read_b128 a[132:135], v212 offset:0
    ds_read_b64_tr_b16 v[128:129], v219 offset:12288
    ds_read_b64_tr_b16 v[130:131], v219 offset:12800
    ds_read_b64_tr_b16 v[132:133], v220 offset:12288
    ds_read_b64_tr_b16 v[134:135], v220 offset:12800
    ds_read_b64_tr_b16 v[136:137], v219 offset:14336
    ds_read_b64_tr_b16 v[138:139], v219 offset:14848
    ds_read_b64_tr_b16 v[140:141], v220 offset:14336
    ds_read_b64_tr_b16 v[142:143], v220 offset:14848
    s_waitcnt lgkmcnt(9)
    v_mfma_f32_32x32x16_bf16 v[0:15], v[112:115], a[128:131], 0
    ds_read_b128 a[136:139], v213 offset:0
    ds_read_b64_tr_b16 v[144:145], v219 offset:20480
    ds_read_b64_tr_b16 v[146:147], v219 offset:20992
    s_add_u32 m0, s46, 69632
    s_add_u32 s43, s43, 1
    s_and_b32 s43, s43, 7
    s_lshl_b32 s44, s43, 7
    s_mul_i32 s45, s43, 229376
    buffer_load_dwordx4 v229, s[12:15], s45 offen lds
    v_mfma_f32_32x32x16_bf16 v[16:31], v[116:119], a[128:131], 0
    ds_read_b64_tr_b16 v[148:149], v220 offset:20480
    ds_read_b64_tr_b16 v[150:151], v220 offset:20992
    buffer_load_dwordx4 v230, s[12:15], s45 offen offset:1024 lds
    v_mfma_f32_32x32x16_bf16 v[32:47], v[120:123], a[128:131], 0
    ds_read_b64_tr_b16 v[152:153], v219 offset:22528
    ds_read_b64_tr_b16 v[154:155], v219 offset:23040
    v_mfma_f32_32x32x16_bf16 v[48:63], v[124:127], a[128:131], 0
    ds_read_b64_tr_b16 v[156:157], v220 offset:22528
    ds_read_b64_tr_b16 v[158:159], v220 offset:23040
    s_waitcnt lgkmcnt(9)
    v_mfma_f32_32x32x16_bf16 v[0:15], v[128:131], a[132:135], v[0:15]
    ds_read_b128 a[140:143], v214 offset:0
    ds_read_b64_tr_b16 v[112:113], v219 offset:28672
    ds_read_b64_tr_b16 v[114:115], v219 offset:29184
    s_add_u32 m0, s46, 71680
    s_nop 0
    buffer_load_dwordx4 v231, s[12:15], s45 offen lds
    v_mfma_f32_32x32x16_bf16 v[16:31], v[132:135], a[132:135], v[16:31]
    ds_read_b64_tr_b16 v[116:117], v220 offset:28672
    ds_read_b64_tr_b16 v[118:119], v220 offset:29184
    v_mfma_f32_32x32x16_bf16 v[32:47], v[136:139], a[132:135], v[32:47]
    ds_read_b64_tr_b16 v[120:121], v219 offset:30720
    ds_read_b64_tr_b16 v[122:123], v219 offset:31232
    buffer_load_dwordx4 v232, s[12:15], s45 offen offset:1024 lds
    v_mfma_f32_32x32x16_bf16 v[48:63], v[140:143], a[132:135], v[48:63]
    ds_read_b64_tr_b16 v[124:125], v220 offset:30720
    ds_read_b64_tr_b16 v[126:127], v220 offset:31232
    s_waitcnt lgkmcnt(9)
    v_mfma_f32_32x32x16_bf16 v[0:15], v[144:147], a[136:139], v[0:15]
    s_waitcnt lgkmcnt(0) vmcnt(6)
    s_barrier
    ds_read_b128 a[144:147], v211 offset:32768
    ds_read_b64_tr_b16 v[128:129], v219 offset:36864
    ds_read_b64_tr_b16 v[130:131], v219 offset:37376
    s_add_u32 m0, s46, 65536
    s_nop 0
    buffer_load_dwordx4 v225, s[8:11], s44 offen lds
    v_mfma_f32_32x32x16_bf16 v[16:31], v[148:151], a[136:139], v[16:31]
    ds_read_b64_tr_b16 v[132:133], v220 offset:36864
    ds_read_b64_tr_b16 v[134:135], v220 offset:37376
    buffer_load_dwordx4 v226, s[8:11], s44 offen offset:1024 lds
    v_mfma_f32_32x32x16_bf16 v[32:47], v[152:155], a[136:139], v[32:47]
    ds_read_b64_tr_b16 v[136:137], v219 offset:38912
    ds_read_b64_tr_b16 v[138:139], v219 offset:39424
    v_mfma_f32_32x32x16_bf16 v[48:63], v[156:159], a[136:139], v[48:63]
    ds_read_b64_tr_b16 v[140:141], v220 offset:38912
    ds_read_b64_tr_b16 v[142:143], v220 offset:39424
    v_mfma_f32_32x32x16_bf16 v[0:15], v[112:115], a[140:143], v[0:15]
    ds_read_b128 a[148:151], v212 offset:32768
    ds_read_b64_tr_b16 v[144:145], v219 offset:45056
    ds_read_b64_tr_b16 v[146:147], v219 offset:45568
    buffer_load_dwordx4 v227, s[8:11], s44 offen offset:2048 lds
    v_mfma_f32_32x32x16_bf16 v[16:31], v[116:119], a[140:143], v[16:31]
    ds_read_b64_tr_b16 v[148:149], v220 offset:45056
    ds_read_b64_tr_b16 v[150:151], v220 offset:45568
    v_mfma_f32_32x32x16_bf16 v[32:47], v[120:123], a[140:143], v[32:47]
    ds_read_b64_tr_b16 v[152:153], v219 offset:47104
    ds_read_b64_tr_b16 v[154:155], v219 offset:47616
    buffer_load_dwordx4 v228, s[8:11], s44 offen offset:3072 lds
    v_mfma_f32_32x32x16_bf16 v[48:63], v[124:127], a[140:143], v[48:63]
    ds_read_b64_tr_b16 v[156:157], v220 offset:47104
    ds_read_b64_tr_b16 v[158:159], v220 offset:47616
    s_waitcnt lgkmcnt(9)
    v_mfma_f32_32x32x16_bf16 v[0:15], v[128:131], a[144:147], v[0:15]
    ds_read_b128 a[152:155], v213 offset:32768
    ds_read_b64_tr_b16 v[112:113], v219 offset:53248
    ds_read_b64_tr_b16 v[114:115], v219 offset:53760
    s_add_u32 m0, s46, 102400
    s_add_u32 s43, s43, 1
    s_and_b32 s43, s43, 7
    s_lshl_b32 s44, s43, 7
    s_mul_i32 s45, s43, 229376
    buffer_load_dwordx4 v229, s[12:15], s45 offen lds
    v_mfma_f32_32x32x16_bf16 v[16:31], v[132:135], a[144:147], v[16:31]
    ds_read_b64_tr_b16 v[116:117], v220 offset:53248
    ds_read_b64_tr_b16 v[118:119], v220 offset:53760
    v_mfma_f32_32x32x16_bf16 v[32:47], v[136:139], a[144:147], v[32:47]
    ds_read_b64_tr_b16 v[120:121], v219 offset:55296
    ds_read_b64_tr_b16 v[122:123], v219 offset:55808
    buffer_load_dwordx4 v230, s[12:15], s45 offen offset:1024 lds
    v_mfma_f32_32x32x16_bf16 v[48:63], v[140:143], a[144:147], v[48:63]
    ds_read_b64_tr_b16 v[124:125], v220 offset:55296
    ds_read_b64_tr_b16 v[126:127], v220 offset:55808
    s_waitcnt lgkmcnt(9)
    v_mfma_f32_32x32x16_bf16 v[0:15], v[144:147], a[148:151], v[0:15]
    ds_read_b128 a[156:159], v214 offset:32768
    ds_read_b64_tr_b16 v[128:129], v219 offset:61440
    ds_read_b64_tr_b16 v[130:131], v219 offset:61952
    s_add_u32 m0, s46, 104448
    s_nop 0
    buffer_load_dwordx4 v231, s[12:15], s45 offen lds
    v_mfma_f32_32x32x16_bf16 v[16:31], v[148:151], a[148:151], v[16:31]
    ds_read_b64_tr_b16 v[132:133], v220 offset:61440
    ds_read_b64_tr_b16 v[134:135], v220 offset:61952
    v_mfma_f32_32x32x16_bf16 v[32:47], v[152:155], a[148:151], v[32:47]
    ds_read_b64_tr_b16 v[136:137], v219 offset:63488
    ds_read_b64_tr_b16 v[138:139], v219 offset:64000
    v_mfma_f32_32x32x16_bf16 v[48:63], v[156:159], a[148:151], v[48:63]
    ds_read_b64_tr_b16 v[140:141], v220 offset:63488
    ds_read_b64_tr_b16 v[142:143], v220 offset:64000
    buffer_load_dwordx4 v232, s[12:15], s45 offen offset:1024 lds
    s_waitcnt lgkmcnt(9)
    v_mfma_f32_32x32x16_bf16 v[0:15], v[112:115], a[152:155], v[0:15]
    s_add_u32 m0, s46, 98304
    s_nop 0
    buffer_load_dwordx4 v225, s[8:11], s44 offen lds
    buffer_load_dwordx4 v226, s[8:11], s44 offen offset:1024 lds
    buffer_load_dwordx4 v227, s[8:11], s44 offen offset:2048 lds
    buffer_load_dwordx4 v228, s[8:11], s44 offen offset:3072 lds
    s_add_u32 m0, s46, 4096
    s_add_u32 s43, s43, 1
    s_and_b32 s43, s43, 7
    s_lshl_b32 s44, s43, 7
    s_mul_i32 s45, s43, 229376
    buffer_load_dwordx4 v229, s[12:15], s45 offen lds
    buffer_load_dwordx4 v230, s[12:15], s45 offen offset:1024 lds
    s_add_u32 m0, s46, 6144
    s_nop 0
    buffer_load_dwordx4 v231, s[12:15], s45 offen lds
    buffer_load_dwordx4 v232, s[12:15], s45 offen offset:1024 lds
    s_add_u32 m0, s46, 0
    s_nop 0
    buffer_load_dwordx4 v225, s[8:11], s44 offen lds
    buffer_load_dwordx4 v226, s[8:11], s44 offen offset:1024 lds
    buffer_load_dwordx4 v227, s[8:11], s44 offen offset:2048 lds
    s_waitcnt lgkmcnt(0) vmcnt(15)
    s_barrier
    ds_read_b128 a[160:163], v215 offset:0
    ds_read_b64_tr_b16 v[144:145], v221 offset:4096
    ds_read_b64_tr_b16 v[146:147], v221 offset:4608
    v_mfma_f32_32x32x16_bf16 v[16:31], v[116:119], a[152:155], v[16:31]
    ds_read_b64_tr_b16 v[148:149], v222 offset:4096
    ds_read_b64_tr_b16 v[150:151], v222 offset:4608
    buffer_load_dwordx4 v228, s[8:11], s44 offen offset:3072 lds
    v_mfma_f32_32x32x16_bf16 v[32:47], v[120:123], a[152:155], v[32:47]
    ds_read_b64_tr_b16 v[152:153], v221 offset:6144
    ds_read_b64_tr_b16 v[154:155], v221 offset:6656
    v_mfma_f32_32x32x16_bf16 v[48:63], v[124:127], a[152:155], v[48:63]
    ds_read_b64_tr_b16 v[156:157], v222 offset:6144
    ds_read_b64_tr_b16 v[158:159], v222 offset:6656
    buffer_load_dword v65, v64, s[16:19], s99 offen
    v_mfma_f32_32x32x16_bf16 v[0:15], v[128:131], a[156:159], v[0:15]
    ds_read_b128 a[164:167], v216 offset:0
    ds_read_b64_tr_b16 v[112:113], v221 offset:12288
    ds_read_b64_tr_b16 v[114:115], v221 offset:12800
    buffer_load_dword v65, v66, s[20:23], s3 offen
    v_mfma_f32_32x32x16_bf16 v[16:31], v[132:135], a[156:159], v[16:31]
    ds_read_b64_tr_b16 v[116:117], v222 offset:12288
    ds_read_b64_tr_b16 v[118:119], v222 offset:12800
    s_add_u32 m0, s46, 36864
    s_add_u32 s43, s43, 1
    s_and_b32 s43, s43, 7
    s_lshl_b32 s44, s43, 7
    s_mul_i32 s45, s43, 229376
    buffer_load_dwordx4 v229, s[12:15], s45 offen lds
    v_mfma_f32_32x32x16_bf16 v[32:47], v[136:139], a[156:159], v[32:47]
    ds_read_b64_tr_b16 v[120:121], v221 offset:14336
    ds_read_b64_tr_b16 v[122:123], v221 offset:14848
    v_mfma_f32_32x32x16_bf16 v[48:63], v[140:143], a[156:159], v[48:63]
    ds_read_b64_tr_b16 v[124:125], v222 offset:14336
    ds_read_b64_tr_b16 v[126:127], v222 offset:14848
    buffer_load_dwordx4 v230, s[12:15], s45 offen offset:1024 lds
    s_waitcnt lgkmcnt(9)
    v_mfma_f32_32x32x16_bf16 v[0:15], v[144:147], a[160:163], v[0:15]
    ds_read_b128 a[168:171], v217 offset:0
    ds_read_b64_tr_b16 v[128:129], v221 offset:20480
    ds_read_b64_tr_b16 v[130:131], v221 offset:20992
    v_mfma_f32_32x32x16_bf16 v[16:31], v[148:151], a[160:163], v[16:31]
    ds_read_b64_tr_b16 v[132:133], v222 offset:20480
    ds_read_b64_tr_b16 v[134:135], v222 offset:20992
    v_mfma_f32_32x32x16_bf16 v[32:47], v[152:155], a[160:163], v[32:47]
    ds_read_b64_tr_b16 v[136:137], v221 offset:22528
    ds_read_b64_tr_b16 v[138:139], v221 offset:23040
    s_add_u32 m0, s46, 38912
    s_nop 0
    buffer_load_dwordx4 v231, s[12:15], s45 offen lds
    v_mfma_f32_32x32x16_bf16 v[48:63], v[156:159], a[160:163], v[48:63]
    ds_read_b64_tr_b16 v[140:141], v222 offset:22528
    ds_read_b64_tr_b16 v[142:143], v222 offset:23040
    s_waitcnt lgkmcnt(9)
    v_mfma_f32_32x32x16_bf16 v[0:15], v[112:115], a[164:167], v[0:15]
    ds_read_b128 a[172:175], v218 offset:0
    ds_read_b64_tr_b16 v[144:145], v221 offset:28672
    ds_read_b64_tr_b16 v[146:147], v221 offset:29184
    buffer_load_dwordx4 v232, s[12:15], s45 offen offset:1024 lds
    v_mfma_f32_32x32x16_bf16 v[16:31], v[116:119], a[164:167], v[16:31]
    ds_read_b64_tr_b16 v[148:149], v222 offset:28672
    ds_read_b64_tr_b16 v[150:151], v222 offset:29184
    v_mfma_f32_32x32x16_bf16 v[32:47], v[120:123], a[164:167], v[32:47]
    ds_read_b64_tr_b16 v[152:153], v221 offset:30720
    ds_read_b64_tr_b16 v[154:155], v221 offset:31232
    s_add_u32 m0, s46, 32768
    s_nop 0
    buffer_load_dwordx4 v225, s[8:11], s44 offen lds
    v_mfma_f32_32x32x16_bf16 v[48:63], v[124:127], a[164:167], v[48:63]
    ds_read_b64_tr_b16 v[156:157], v222 offset:30720
    ds_read_b64_tr_b16 v[158:159], v222 offset:31232
    s_waitcnt lgkmcnt(9)
    v_mfma_f32_32x32x16_bf16 v[0:15], v[128:131], a[168:171], v[0:15]
    buffer_load_dwordx4 v226, s[8:11], s44 offen offset:1024 lds
    buffer_load_dwordx4 v227, s[8:11], s44 offen offset:2048 lds
    s_waitcnt lgkmcnt(0) vmcnt(17)
    s_barrier
    ds_read_b128 a[176:179], v215 offset:32768
    ds_read_b64_tr_b16 v[112:113], v221 offset:36864
    ds_read_b64_tr_b16 v[114:115], v221 offset:37376
    v_mfma_f32_32x32x16_bf16 v[16:31], v[132:135], a[168:171], v[16:31]
    ds_read_b64_tr_b16 v[116:117], v222 offset:36864
    ds_read_b64_tr_b16 v[118:119], v222 offset:37376
    v_mfma_f32_32x32x16_bf16 v[32:47], v[136:139], a[168:171], v[32:47]
    ds_read_b64_tr_b16 v[120:121], v221 offset:38912
    ds_read_b64_tr_b16 v[122:123], v221 offset:39424
    v_mfma_f32_32x32x16_bf16 v[48:63], v[140:143], a[168:171], v[48:63]
    ds_read_b64_tr_b16 v[124:125], v222 offset:38912
    ds_read_b64_tr_b16 v[126:127], v222 offset:39424
    buffer_load_dwordx4 v228, s[8:11], s44 offen offset:3072 lds
    v_mfma_f32_32x32x16_bf16 v[0:15], v[144:147], a[172:175], v[0:15]
    ds_read_b128 a[180:183], v216 offset:32768
    ds_read_b64_tr_b16 v[128:129], v221 offset:45056
    ds_read_b64_tr_b16 v[130:131], v221 offset:45568
    v_mfma_f32_32x32x16_bf16 v[16:31], v[148:151], a[172:175], v[16:31]
    ds_read_b64_tr_b16 v[132:133], v222 offset:45056
    ds_read_b64_tr_b16 v[134:135], v222 offset:45568
    s_add_u32 m0, s46, 69632
    s_add_u32 s43, s43, 1
    s_and_b32 s43, s43, 7
    s_lshl_b32 s44, s43, 7
    s_mul_i32 s45, s43, 229376
    buffer_load_dwordx4 v229, s[12:15], s45 offen lds
    v_mfma_f32_32x32x16_bf16 v[32:47], v[152:155], a[172:175], v[32:47]
    ds_read_b64_tr_b16 v[136:137], v221 offset:47104
    ds_read_b64_tr_b16 v[138:139], v221 offset:47616
    v_mfma_f32_32x32x16_bf16 v[48:63], v[156:159], a[172:175], v[48:63]
    ds_read_b64_tr_b16 v[140:141], v222 offset:47104
    ds_read_b64_tr_b16 v[142:143], v222 offset:47616
    buffer_load_dwordx4 v230, s[12:15], s45 offen offset:1024 lds
    s_waitcnt lgkmcnt(9)
    v_mfma_f32_32x32x16_bf16 v[0:15], v[112:115], a[176:179], v[0:15]
    ds_read_b128 a[184:187], v217 offset:32768
    ds_read_b64_tr_b16 v[144:145], v221 offset:53248
    ds_read_b64_tr_b16 v[146:147], v221 offset:53760
    v_mfma_f32_32x32x16_bf16 v[16:31], v[116:119], a[176:179], v[16:31]
    ds_read_b64_tr_b16 v[148:149], v222 offset:53248
    ds_read_b64_tr_b16 v[150:151], v222 offset:53760
    s_add_u32 m0, s46, 71680
    s_nop 0
    buffer_load_dwordx4 v231, s[12:15], s45 offen lds
    v_mfma_f32_32x32x16_bf16 v[32:47], v[120:123], a[176:179], v[32:47]
    ds_read_b64_tr_b16 v[152:153], v221 offset:55296
    ds_read_b64_tr_b16 v[154:155], v221 offset:55808
    v_mfma_f32_32x32x16_bf16 v[48:63], v[124:127], a[176:179], v[48:63]
    ds_read_b64_tr_b16 v[156:157], v222 offset:55296
    ds_read_b64_tr_b16 v[158:159], v222 offset:55808
    buffer_load_dwordx4 v232, s[12:15], s45 offen offset:1024 lds
    s_waitcnt lgkmcnt(9)
    v_mfma_f32_32x32x16_bf16 v[0:15], v[128:131], a[180:183], v[0:15]
    ds_read_b128 a[188:191], v218 offset:32768
    ds_read_b64_tr_b16 v[112:113], v221 offset:61440
    ds_read_b64_tr_b16 v[114:115], v221 offset:61952
    v_mfma_f32_32x32x16_bf16 v[16:31], v[132:135], a[180:183], v[16:31]
    ds_read_b64_tr_b16 v[116:117], v222 offset:61440
    ds_read_b64_tr_b16 v[118:119], v222 offset:61952
    v_mfma_f32_32x32x16_bf16 v[32:47], v[136:139], a[180:183], v[32:47]
    ds_read_b64_tr_b16 v[120:121], v221 offset:63488
    ds_read_b64_tr_b16 v[122:123], v221 offset:64000
    s_add_u32 m0, s46, 65536
    s_nop 0
    buffer_load_dwordx4 v225, s[8:11], s44 offen lds
    v_mfma_f32_32x32x16_bf16 v[48:63], v[140:143], a[180:183], v[48:63]
    ds_read_b64_tr_b16 v[124:125], v222 offset:63488
    ds_read_b64_tr_b16 v[126:127], v222 offset:64000
    s_waitcnt lgkmcnt(9)
    v_mfma_f32_32x32x16_bf16 v[0:15], v[144:147], a[184:187], v[0:15]
    buffer_load_dwordx4 v226, s[8:11], s44 offen offset:1024 lds
    buffer_load_dwordx4 v227, s[8:11], s44 offen offset:2048 lds
    s_waitcnt lgkmcnt(0) vmcnt(17)
    s_barrier
    ds_read_b128 a[192:195], v211 offset:0
    ds_read_b64_tr_b16 v[128:129], v219 offset:4096
    ds_read_b64_tr_b16 v[130:131], v219 offset:4608
    v_mfma_f32_32x32x16_bf16 v[16:31], v[148:151], a[184:187], v[16:31]
    ds_read_b64_tr_b16 v[132:133], v220 offset:4096
    ds_read_b64_tr_b16 v[134:135], v220 offset:4608
    v_mfma_f32_32x32x16_bf16 v[32:47], v[152:155], a[184:187], v[32:47]
    ds_read_b64_tr_b16 v[136:137], v219 offset:6144
    ds_read_b64_tr_b16 v[138:139], v219 offset:6656
    buffer_load_dwordx4 v228, s[8:11], s44 offen offset:3072 lds
    v_mfma_f32_32x32x16_bf16 v[48:63], v[156:159], a[184:187], v[48:63]
    ds_read_b64_tr_b16 v[140:141], v220 offset:6144
    ds_read_b64_tr_b16 v[142:143], v220 offset:6656
    v_mfma_f32_32x32x16_bf16 v[0:15], v[112:115], a[188:191], v[0:15]
    ds_read_b128 a[196:199], v212 offset:0
    ds_read_b64_tr_b16 v[144:145], v219 offset:12288
    ds_read_b64_tr_b16 v[146:147], v219 offset:12800
    s_add_u32 m0, s46, 102400
    s_add_u32 s43, s43, 1
    s_and_b32 s43, s43, 7
    s_lshl_b32 s44, s43, 7
    s_mul_i32 s45, s43, 229376
    buffer_load_dwordx4 v229, s[12:15], s45 offen lds
    v_mfma_f32_32x32x16_bf16 v[16:31], v[116:119], a[188:191], v[16:31]
    ds_read_b64_tr_b16 v[148:149], v220 offset:12288
    ds_read_b64_tr_b16 v[150:151], v220 offset:12800
    v_mfma_f32_32x32x16_bf16 v[32:47], v[120:123], a[188:191], v[32:47]
    ds_read_b64_tr_b16 v[152:153], v219 offset:14336
    ds_read_b64_tr_b16 v[154:155], v219 offset:14848
    buffer_load_dwordx4 v230, s[12:15], s45 offen offset:1024 lds
    v_mfma_f32_32x32x16_bf16 v[48:63], v[124:127], a[188:191], v[48:63]
    ds_read_b64_tr_b16 v[156:157], v220 offset:14336
    ds_read_b64_tr_b16 v[158:159], v220 offset:14848
    s_waitcnt lgkmcnt(9)
    v_mfma_f32_32x32x16_bf16 v[0:15], v[128:131], a[192:195], v[0:15]
    ds_read_b128 a[200:203], v213 offset:0
    ds_read_b64_tr_b16 v[112:113], v219 offset:20480
    ds_read_b64_tr_b16 v[114:115], v219 offset:20992
    v_mfma_f32_32x32x16_bf16 v[16:31], v[132:135], a[192:195], v[16:31]
    ds_read_b64_tr_b16 v[116:117], v220 offset:20480
    ds_read_b64_tr_b16 v[118:119], v220 offset:20992
    s_add_u32 m0, s46, 104448
    s_nop 0
    buffer_load_dwordx4 v231, s[12:15], s45 offen lds
    v_mfma_f32_32x32x16_bf16 v[32:47], v[136:139], a[192:195], v[32:47]
    ds_read_b64_tr_b16 v[120:121], v219 offset:22528
    ds_read_b64_tr_b16 v[122:123], v219 offset:23040
    v_mfma_f32_32x32x16_bf16 v[48:63], v[140:143], a[192:195], v[48:63]
    ds_read_b64_tr_b16 v[124:125], v220 offset:22528
    ds_read_b64_tr_b16 v[126:127], v220 offset:23040
    buffer_load_dwordx4 v232, s[12:15], s45 offen offset:1024 lds
    s_waitcnt lgkmcnt(9)
    v_mfma_f32_32x32x16_bf16 v[0:15], v[144:147], a[196:199], v[0:15]
    ds_read_b128 a[204:207], v214 offset:0
    ds_read_b64_tr_b16 v[128:129], v219 offset:28672
    ds_read_b64_tr_b16 v[130:131], v219 offset:29184
    v_mfma_f32_32x32x16_bf16 v[16:31], v[148:151], a[196:199], v[16:31]
    ds_read_b64_tr_b16 v[132:133], v220 offset:28672
    ds_read_b64_tr_b16 v[134:135], v220 offset:29184
    s_add_u32 m0, s46, 98304
    s_nop 0
    buffer_load_dwordx4 v225, s[8:11], s44 offen lds
    v_mfma_f32_32x32x16_bf16 v[32:47], v[152:155], a[196:199], v[32:47]
    ds_read_b64_tr_b16 v[136:137], v219 offset:30720
    ds_read_b64_tr_b16 v[138:139], v219 offset:31232
    v_mfma_f32_32x32x16_bf16 v[48:63], v[156:159], a[196:199], v[48:63]
    ds_read_b64_tr_b16 v[140:141], v220 offset:30720
    ds_read_b64_tr_b16 v[142:143], v220 offset:31232
    buffer_load_dwordx4 v226, s[8:11], s44 offen offset:1024 lds
    s_waitcnt lgkmcnt(9)
    v_mfma_f32_32x32x16_bf16 v[0:15], v[112:115], a[200:203], v[0:15]
    buffer_load_dwordx4 v227, s[8:11], s44 offen offset:2048 lds
    s_waitcnt lgkmcnt(0) vmcnt(15)
    s_barrier
    ds_read_b128 a[208:211], v211 offset:32768
    ds_read_b64_tr_b16 v[144:145], v219 offset:36864
    ds_read_b64_tr_b16 v[146:147], v219 offset:37376
    v_mfma_f32_32x32x16_bf16 v[16:31], v[116:119], a[200:203], v[16:31]
    ds_read_b64_tr_b16 v[148:149], v220 offset:36864
    ds_read_b64_tr_b16 v[150:151], v220 offset:37376
    buffer_load_dwordx4 v228, s[8:11], s44 offen offset:3072 lds
    v_add_u32 v225, s86, v242
    v_add_u32 v226, 114688, v225
    v_mfma_f32_32x32x16_bf16 v[32:47], v[120:123], a[200:203], v[32:47]
    ds_read_b64_tr_b16 v[152:153], v219 offset:38912
    ds_read_b64_tr_b16 v[154:155], v219 offset:39424
    v_add_u32 v227, s87, v242
    v_add_u32 v228, 32768, v227
    v_add_u32 v229, 11534336, v242
    v_mfma_f32_32x32x16_bf16 v[48:63], v[124:127], a[200:203], v[48:63]
    ds_read_b64_tr_b16 v[156:157], v220 offset:38912
    ds_read_b64_tr_b16 v[158:159], v220 offset:39424
    s_add_u32 m0, s46, 0
    s_add_u32 s43, s43, 1
    s_and_b32 s43, s43, 7
    s_mul_i32 s45, s43, 229376
    buffer_load_dwordx4 v208, s[12:15], s45 offen lds
    v_mfma_f32_32x32x16_bf16 v[0:15], v[128:131], a[204:207], v[0:15]
    ds_read_b128 a[212:215], v212 offset:32768
    ds_read_b64_tr_b16 v[112:113], v219 offset:45056
    ds_read_b64_tr_b16 v[114:115], v219 offset:45568
    v_lshrrev_b32 v252, 5, v241
    v_and_b32 v231, 31, v241
    v_mfma_f32_32x32x16_bf16 v[16:31], v[132:135], a[204:207], v[16:31]
    ds_read_b64_tr_b16 v[116:117], v220 offset:45056
    ds_read_b64_tr_b16 v[118:119], v220 offset:45568
    v_lshlrev_b32 v231, 2, v231
    buffer_load_dwordx4 v209, s[12:15], s45 offen offset:1024 lds
    v_lshl_add_u32 v231, v252, 8, v231
    v_mfma_f32_32x32x16_bf16 v[32:47], v[136:139], a[204:207], v[32:47]
    ds_read_b64_tr_b16 v[120:121], v219 offset:47104
    ds_read_b64_tr_b16 v[122:123], v219 offset:47616
    v_lshlrev_b32 v232, 3, v241
    buffer_load_dword v243, off, s[36:39], 0 sc1
    v_mfma_f32_32x32x16_bf16 v[48:63], v[140:143], a[204:207], v[48:63]
    ds_read_b64_tr_b16 v[124:125], v220 offset:47104
    ds_read_b64_tr_b16 v[126:127], v220 offset:47616
    s_waitcnt lgkmcnt(9)
    v_mfma_f32_32x32x16_bf16 v[0:15], v[144:147], a[208:211], v[0:15]
    ds_read_b128 a[216:219], v213 offset:32768
    ds_read_b64_tr_b16 v[128:129], v219 offset:53248
    ds_read_b64_tr_b16 v[130:131], v219 offset:53760
    s_add_u32 m0, s46, 4096
    s_nop 0
    buffer_load_dwordx4 v210, s[12:15], s45 offen lds
    v_mfma_f32_32x32x16_bf16 v[16:31], v[148:151], a[208:211], v[16:31]
    ds_read_b64_tr_b16 v[132:133], v220 offset:53248
    ds_read_b64_tr_b16 v[134:135], v220 offset:53760
    v_mfma_f32_32x32x16_bf16 v[32:47], v[152:155], a[208:211], v[32:47]
    ds_read_b64_tr_b16 v[136:137], v219 offset:55296
    ds_read_b64_tr_b16 v[138:139], v219 offset:55808
    v_mfma_f32_32x32x16_bf16 v[48:63], v[156:159], a[208:211], v[48:63]
    ds_read_b64_tr_b16 v[140:141], v220 offset:55296
    ds_read_b64_tr_b16 v[142:143], v220 offset:55808
    s_add_u32 m0, s46, 2048
    s_add_u32 s43, s43, 1
    s_and_b32 s43, s43, 7
    s_mul_i32 s45, s43, 229376
    buffer_load_dwordx4 v208, s[12:15], s45 offen lds
    s_waitcnt lgkmcnt(9)
    v_mfma_f32_32x32x16_bf16 v[0:15], v[112:115], a[212:215], v[0:15]
    ds_read_b128 a[220:223], v214 offset:32768
    ds_read_b64_tr_b16 v[144:145], v219 offset:61440
    ds_read_b64_tr_b16 v[146:147], v219 offset:61952
    v_mfma_f32_32x32x16_bf16 v[16:31], v[116:119], a[212:215], v[16:31]
    ds_read_b64_tr_b16 v[148:149], v220 offset:61440
    ds_read_b64_tr_b16 v[150:151], v220 offset:61952
    buffer_load_dwordx4 v209, s[12:15], s45 offen offset:1024 lds
    v_mfma_f32_32x32x16_bf16 v[32:47], v[120:123], a[212:215], v[32:47]
    ds_read_b64_tr_b16 v[152:153], v219 offset:63488
    ds_read_b64_tr_b16 v[154:155], v219 offset:64000
    v_mfma_f32_32x32x16_bf16 v[48:63], v[124:127], a[212:215], v[48:63]
    ds_read_b64_tr_b16 v[156:157], v220 offset:63488
    ds_read_b64_tr_b16 v[158:159], v220 offset:64000
    s_add_u32 m0, s46, 5120
    s_nop 0
    buffer_load_dwordx4 v210, s[12:15], s45 offen lds
    s_waitcnt lgkmcnt(9)
    v_mfma_f32_32x32x16_bf16 v[0:15], v[128:131], a[216:219], v[0:15]
    s_waitcnt lgkmcnt(0) vmcnt(15)
    s_barrier
    ds_read_b128 a[224:227], v215 offset:0
    ds_read_b64_tr_b16 v[112:113], v221 offset:4096
    ds_read_b64_tr_b16 v[114:115], v221 offset:4608
    s_add_u32 m0, s46, 32768
    s_add_u32 s43, s43, 1
    s_and_b32 s43, s43, 7
    s_mul_i32 s45, s43, 229376
    buffer_load_dwordx4 v208, s[12:15], s45 offen lds
    v_mfma_f32_32x32x16_bf16 v[16:31], v[132:135], a[216:219], v[16:31]
    ds_read_b64_tr_b16 v[116:117], v222 offset:4096
    ds_read_b64_tr_b16 v[118:119], v222 offset:4608
    buffer_load_dwordx4 v209, s[12:15], s45 offen offset:1024 lds
    v_mfma_f32_32x32x16_bf16 v[32:47], v[136:139], a[216:219], v[32:47]
    ds_read_b64_tr_b16 v[120:121], v221 offset:6144
    ds_read_b64_tr_b16 v[122:123], v221 offset:6656
    v_mfma_f32_32x32x16_bf16 v[48:63], v[140:143], a[216:219], v[48:63]
    ds_read_b64_tr_b16 v[124:125], v222 offset:6144
    ds_read_b64_tr_b16 v[126:127], v222 offset:6656
    v_mfma_f32_32x32x16_bf16 v[0:15], v[144:147], a[220:223], v[0:15]
    ds_read_b128 a[228:231], v216 offset:0
    ds_read_b64_tr_b16 v[128:129], v221 offset:12288
    ds_read_b64_tr_b16 v[130:131], v221 offset:12800
    s_add_u32 m0, s46, 36864
    s_nop 0
    buffer_load_dwordx4 v210, s[12:15], s45 offen lds
    v_mfma_f32_32x32x16_bf16 v[16:31], v[148:151], a[220:223], v[16:31]
    ds_read_b64_tr_b16 v[132:133], v222 offset:12288
    ds_read_b64_tr_b16 v[134:135], v222 offset:12800
    v_mfma_f32_32x32x16_bf16 v[32:47], v[152:155], a[220:223], v[32:47]
    ds_read_b64_tr_b16 v[136:137], v221 offset:14336
    ds_read_b64_tr_b16 v[138:139], v221 offset:14848
    s_add_u32 m0, s46, 34816
    s_add_u32 s43, s43, 1
    s_and_b32 s43, s43, 7
    s_mul_i32 s45, s43, 229376
    buffer_load_dwordx4 v208, s[12:15], s45 offen lds
    v_mfma_f32_32x32x16_bf16 v[48:63], v[156:159], a[220:223], v[48:63]
    ds_read_b64_tr_b16 v[140:141], v222 offset:14336
    ds_read_b64_tr_b16 v[142:143], v222 offset:14848
    s_waitcnt lgkmcnt(9)
    v_mfma_f32_32x32x16_bf16 v[0:15], v[112:115], a[224:227], v[0:15]
    ds_read_b128 a[232:235], v217 offset:0
    ds_read_b64_tr_b16 v[144:145], v221 offset:20480
    ds_read_b64_tr_b16 v[146:147], v221 offset:20992
    buffer_load_dwordx4 v209, s[12:15], s45 offen offset:1024 lds
    v_mfma_f32_32x32x16_bf16 v[16:31], v[116:119], a[224:227], v[16:31]
    ds_read_b64_tr_b16 v[148:149], v222 offset:20480
    ds_read_b64_tr_b16 v[150:151], v222 offset:20992
    v_mfma_f32_32x32x16_bf16 v[32:47], v[120:123], a[224:227], v[32:47]
    ds_read_b64_tr_b16 v[152:153], v221 offset:22528
    ds_read_b64_tr_b16 v[154:155], v221 offset:23040
    s_add_u32 m0, s46, 37888
    s_nop 0
    buffer_load_dwordx4 v210, s[12:15], s45 offen lds
    v_mfma_f32_32x32x16_bf16 v[48:63], v[124:127], a[224:227], v[48:63]
    ds_read_b64_tr_b16 v[156:157], v222 offset:22528
    ds_read_b64_tr_b16 v[158:159], v222 offset:23040
    s_waitcnt lgkmcnt(9)
    v_mfma_f32_32x32x16_bf16 v[0:15], v[128:131], a[228:231], v[0:15]
    ds_read_b128 a[236:239], v218 offset:0
    ds_read_b64_tr_b16 v[112:113], v221 offset:28672
    ds_read_b64_tr_b16 v[114:115], v221 offset:29184
    v_mfma_f32_32x32x16_bf16 v[16:31], v[132:135], a[228:231], v[16:31]
    ds_read_b64_tr_b16 v[116:117], v222 offset:28672
    ds_read_b64_tr_b16 v[118:119], v222 offset:29184
    v_mfma_f32_32x32x16_bf16 v[32:47], v[136:139], a[228:231], v[32:47]
    ds_read_b64_tr_b16 v[120:121], v221 offset:30720
    ds_read_b64_tr_b16 v[122:123], v221 offset:31232
    v_mfma_f32_32x32x16_bf16 v[48:63], v[140:143], a[228:231], v[48:63]
    ds_read_b64_tr_b16 v[124:125], v222 offset:30720
    ds_read_b64_tr_b16 v[126:127], v222 offset:31232
    s_waitcnt lgkmcnt(9)
    v_mfma_f32_32x32x16_bf16 v[0:15], v[144:147], a[232:235], v[0:15]
    s_waitcnt lgkmcnt(0) vmcnt(13)
    s_barrier
    ds_read_b128 a[240:243], v215 offset:32768
    ds_read_b64_tr_b16 v[128:129], v221 offset:36864
    ds_read_b64_tr_b16 v[130:131], v221 offset:37376
    s_add_u32 m0, s46, 65536
    s_add_u32 s43, s43, 1
    s_and_b32 s43, s43, 7
    s_mul_i32 s45, s43, 229376
    buffer_load_dwordx4 v208, s[12:15], s45 offen lds
    v_mfma_f32_32x32x16_bf16 v[16:31], v[148:151], a[232:235], v[16:31]
    ds_read_b64_tr_b16 v[132:133], v222 offset:36864
    ds_read_b64_tr_b16 v[134:135], v222 offset:37376
    buffer_load_dwordx4 v209, s[12:15], s45 offen offset:1024 lds
    v_mfma_f32_32x32x16_bf16 v[32:47], v[152:155], a[232:235], v[32:47]
    ds_read_b64_tr_b16 v[136:137], v221 offset:38912
    ds_read_b64_tr_b16 v[138:139], v221 offset:39424
    v_mfma_f32_32x32x16_bf16 v[48:63], v[156:159], a[232:235], v[48:63]
    ds_read_b64_tr_b16 v[140:141], v222 offset:38912
    ds_read_b64_tr_b16 v[142:143], v222 offset:39424
    v_mfma_f32_32x32x16_bf16 v[0:15], v[112:115], a[236:239], v[0:15]
    ds_read_b128 a[244:247], v216 offset:32768
    ds_read_b64_tr_b16 v[144:145], v221 offset:45056
    ds_read_b64_tr_b16 v[146:147], v221 offset:45568
    s_waitcnt vmcnt(12)
    v_readfirstlane_b32 s47, v243
    s_cmp_eq_u32 s47, 0
    s_cbranch_scc1 L_spin2
L_ok1:
    v_mov_b32 v230, s47
    s_add_u32 m0, s46, 69632
    s_nop 0
    buffer_load_dwordx4 v210, s[12:15], s45 offen lds
    v_mfma_f32_32x32x16_bf16 v[16:31], v[116:119], a[236:239], v[16:31]
    ds_read_b64_tr_b16 v[148:149], v222 offset:45056
    ds_read_b64_tr_b16 v[150:151], v222 offset:45568
    v_mfma_f32_32x32x16_bf16 v[32:47], v[120:123], a[236:239], v[32:47]
    ds_read_b64_tr_b16 v[152:153], v221 offset:47104
    ds_read_b64_tr_b16 v[154:155], v221 offset:47616
    s_add_u32 m0, s46, 67584
    s_add_u32 s43, s43, 1
    s_and_b32 s43, s43, 7
    s_mul_i32 s45, s43, 229376
    buffer_load_dwordx4 v208, s[12:15], s45 offen lds
    v_mfma_f32_32x32x16_bf16 v[48:63], v[124:127], a[236:239], v[48:63]
    ds_read_b64_tr_b16 v[156:157], v222 offset:47104
    ds_read_b64_tr_b16 v[158:159], v222 offset:47616
    s_waitcnt lgkmcnt(9)
    v_mfma_f32_32x32x16_bf16 v[0:15], v[128:131], a[240:243], v[0:15]
    ds_read_b128 a[248:251], v217 offset:32768
    ds_read_b64_tr_b16 v[112:113], v221 offset:53248
    ds_read_b64_tr_b16 v[114:115], v221 offset:53760
    buffer_load_dwordx4 v209, s[12:15], s45 offen offset:1024 lds
    v_mfma_f32_32x32x16_bf16 v[16:31], v[132:135], a[240:243], v[16:31]
    ds_read_b64_tr_b16 v[116:117], v222 offset:53248
    ds_read_b64_tr_b16 v[118:119], v222 offset:53760
    v_mfma_f32_32x32x16_bf16 v[32:47], v[136:139], a[240:243], v[32:47]
    ds_read_b64_tr_b16 v[120:121], v221 offset:55296
    ds_read_b64_tr_b16 v[122:123], v221 offset:55808
    s_add_u32 m0, s46, 70656
    s_nop 0
    buffer_load_dwordx4 v210, s[12:15], s45 offen lds
    v_mfma_f32_32x32x16_bf16 v[48:63], v[140:143], a[240:243], v[48:63]
    ds_read_b64_tr_b16 v[124:125], v222 offset:55296
    ds_read_b64_tr_b16 v[126:127], v222 offset:55808
    s_waitcnt lgkmcnt(9)
    v_mfma_f32_32x32x16_bf16 v[0:15], v[144:147], a[244:247], v[0:15]
    ds_read_b128 a[252:255], v218 offset:32768
    ds_read_b64_tr_b16 v[128:129], v221 offset:61440
    ds_read_b64_tr_b16 v[130:131], v221 offset:61952
    v_mfma_f32_32x32x16_bf16 v[16:31], v[148:151], a[244:247], v[16:31]
    ds_read_b64_tr_b16 v[132:133], v222 offset:61440
    ds_read_b64_tr_b16 v[134:135], v222 offset:61952
    v_mfma_f32_32x32x16_bf16 v[32:47], v[152:155], a[244:247], v[32:47]
    ds_read_b64_tr_b16 v[136:137], v221 offset:63488
    ds_read_b64_tr_b16 v[138:139], v221 offset:64000
    v_mfma_f32_32x32x16_bf16 v[48:63], v[156:159], a[244:247], v[48:63]
    ds_read_b64_tr_b16 v[140:141], v222 offset:63488
    ds_read_b64_tr_b16 v[142:143], v222 offset:64000
    s_waitcnt lgkmcnt(9)
    v_mfma_f32_32x32x16_bf16 v[0:15], v[112:115], a[248:251], v[0:15]
    s_waitcnt lgkmcnt(0) vmcnt(12)
    s_barrier
    ds_read_b64_tr_b16 v[144:145], v219 offset:0
    ds_read_b64_tr_b16 v[146:147], v219 offset:512
    s_add_u32 m0, s46, 98304
    s_add_u32 s43, s43, 1
    s_and_b32 s43, s43, 7
    s_mul_i32 s45, s43, 229376
    buffer_load_dwordx4 v208, s[12:15], s45 offen lds
    v_mfma_f32_32x32x16_bf16 v[16:31], v[116:119], a[248:251], v[16:31]
    ds_read_b64_tr_b16 v[148:149], v220 offset:0
    v_mfma_f32_32x32x16_bf16 v[32:47], v[120:123], a[248:251], v[32:47]
    ds_read_b64_tr_b16 v[150:151], v220 offset:512
    ds_read_b64_tr_b16 v[152:153], v223 offset:4096
    buffer_load_dwordx4 v209, s[12:15], s45 offen offset:1024 lds
    v_mfma_f32_32x32x16_bf16 v[48:63], v[124:127], a[248:251], v[48:63]
    ds_read_b64_tr_b16 v[154:155], v223 offset:4352
    v_mfma_f32_32x32x16_bf16 v[0:15], v[128:131], a[252:255], v[0:15]
    ds_read_b64_tr_b16 v[112:113], v219 offset:8192
    ds_read_b64_tr_b16 v[114:115], v219 offset:8704
    s_add_u32 m0, s46, 102400
    s_nop 0
    buffer_load_dwordx4 v210, s[12:15], s45 offen lds
    v_mfma_f32_32x32x16_bf16 v[16:31], v[132:135], a[252:255], v[16:31]
    ds_read_b64_tr_b16 v[116:117], v220 offset:8192
    v_mfma_f32_32x32x16_bf16 v[32:47], v[136:139], a[252:255], v[32:47]
    ds_read_b64_tr_b16 v[118:119], v220 offset:8704
    ds_read_b64_tr_b16 v[120:121], v223 offset:12288
    s_add_u32 m0, s46, 100352
    s_add_u32 s43, s43, 1
    s_and_b32 s43, s43, 7
    s_mul_i32 s45, s43, 229376
    buffer_load_dwordx4 v208, s[12:15], s45 offen lds
    v_mfma_f32_32x32x16_bf16 v[48:63], v[140:143], a[252:255], v[48:63]
    ds_read_b64_tr_b16 v[122:123], v223 offset:12544
    v_pk_mul_f32 v[192:193], v[0:1], s[54:55] op_sel_hi:[1,0]
    v_pk_mul_f32 v[194:195], v[2:3], s[54:55] op_sel_hi:[1,0]
    v_pk_mul_f32 v[196:197], v[4:5], s[54:55] op_sel_hi:[1,0]
    v_pk_mul_f32 v[198:199], v[6:7], s[54:55] op_sel_hi:[1,0]
    s_waitcnt lgkmcnt(6)
    v_mfma_f32_32x32x16_bf16 v[64:79], v[144:147], a[128:131], 0
    ds_read_b64_tr_b16 v[128:129], v219 offset:16384
    ds_read_b64_tr_b16 v[130:131], v219 offset:16896
    buffer_load_dwordx4 v209, s[12:15], s45 offen offset:1024 lds
    v_exp_f32 v192, v192
    v_exp_f32 v193, v193
    v_exp_f32 v194, v194
    v_exp_f32 v195, v195
    v_exp_f32 v196, v196
    v_exp_f32 v197, v197
    v_exp_f32 v198, v198
    v_exp_f32 v199, v199
    v_pk_add_f32 v[192:193], v[192:193], 1.0 op_sel_hi:[1,0]
    v_pk_add_f32 v[194:195], v[194:195], 1.0 op_sel_hi:[1,0]
    v_pk_add_f32 v[196:197], v[196:197], 1.0 op_sel_hi:[1,0]
    v_pk_add_f32 v[198:199], v[198:199], 1.0 op_sel_hi:[1,0]
    v_mfma_f32_32x32x16_bf16 v[80:95], v[148:151], a[128:131], 0
    ds_read_b64_tr_b16 v[132:133], v220 offset:16384
    ds_read_b64_tr_b16 v[134:135], v220 offset:16896
    s_add_u32 m0, s46, 103424
    s_nop 0
    buffer_load_dwordx4 v210, s[12:15], s45 offen lds
    v_rcp_f32 v192, v192
    v_rcp_f32 v193, v193
    v_rcp_f32 v194, v194
    v_rcp_f32 v195, v195
    v_rcp_f32 v196, v196
    v_rcp_f32 v197, v197
    v_rcp_f32 v198, v198
    v_rcp_f32 v199, v199
    v_pk_mul_f32 v[0:1], v[0:1], v[192:193]
    v_pk_mul_f32 v[2:3], v[2:3], v[194:195]
    v_pk_mul_f32 v[4:5], v[4:5], v[196:197]
    v_pk_mul_f32 v[6:7], v[6:7], v[198:199]
    v_mfma_f32_32x32x16_bf16 v[96:111], v[152:155], a[128:131], 0
    ds_read_b64_tr_b16 v[136:137], v223 offset:20480
    ds_read_b64_tr_b16 v[138:139], v223 offset:20736
    v_cvt_pk_bf16_f32 v0, v0, v1
    v_cvt_pk_bf16_f32 v1, v2, v3
    v_cvt_pk_bf16_f32 v2, v4, v5
    v_cvt_pk_bf16_f32 v3, v6, v7
    buffer_store_dwordx4 v[0:3], v244, s[24:27], s57 offen offset:0 sc1
    v_pk_mul_f32 v[200:201], v[8:9], s[54:55] op_sel_hi:[1,0]
    v_pk_mul_f32 v[202:203], v[10:11], s[54:55] op_sel_hi:[1,0]
    v_pk_mul_f32 v[204:205], v[12:13], s[54:55] op_sel_hi:[1,0]
    v_pk_mul_f32 v[206:207], v[14:15], s[54:55] op_sel_hi:[1,0]
    v_exp_f32 v200, v200
    v_exp_f32 v201, v201
    v_exp_f32 v202, v202
    v_exp_f32 v203, v203
    v_exp_f32 v204, v204
    v_exp_f32 v205, v205
    s_waitcnt lgkmcnt(6)
    v_mfma_f32_32x32x16_bf16 v[64:79], v[112:115], a[132:135], v[64:79]
    ds_read_b64_tr_b16 v[144:145], v219 offset:24576
    ds_read_b64_tr_b16 v[146:147], v219 offset:25088
    s_add_u32 m0, s46, 131072
    s_lshl4_add_u32 s48, s64, 0
    buffer_load_dwordx4 v233, s[16:19], s48 offen lds
    v_exp_f32 v206, v206
    v_exp_f32 v207, v207
    v_pk_add_f32 v[200:201], v[200:201], 1.0 op_sel_hi:[1,0]
    v_pk_add_f32 v[202:203], v[202:203], 1.0 op_sel_hi:[1,0]
    v_pk_add_f32 v[204:205], v[204:205], 1.0 op_sel_hi:[1,0]
    v_pk_add_f32 v[206:207], v[206:207], 1.0 op_sel_hi:[1,0]
    v_rcp_f32 v200, v200
    v_rcp_f32 v201, v201
    v_rcp_f32 v202, v202
    v_rcp_f32 v203, v203
    v_rcp_f32 v204, v204
    v_rcp_f32 v205, v205
    v_mfma_f32_32x32x16_bf16 v[80:95], v[116:119], a[132:135], v[80:95]
    ds_read_b64_tr_b16 v[148:149], v220 offset:24576
    ds_read_b64_tr_b16 v[150:151], v220 offset:25088
    buffer_load_dwordx4 v234, s[16:19], s48 offen offset:1024 lds
    v_rcp_f32 v206, v206
    v_rcp_f32 v207, v207
    v_pk_mul_f32 v[8:9], v[8:9], v[200:201]
    v_pk_mul_f32 v[10:11], v[10:11], v[202:203]
    v_pk_mul_f32 v[12:13], v[12:13], v[204:205]
    v_pk_mul_f32 v[14:15], v[14:15], v[206:207]
    v_cvt_pk_bf16_f32 v8, v8, v9
    v_cvt_pk_bf16_f32 v9, v10, v11
    v_cvt_pk_bf16_f32 v10, v12, v13
    v_cvt_pk_bf16_f32 v11, v14, v15
    buffer_store_dwordx4 v[8:11], v244, s[24:27], s57 offen offset:1024 sc1
    v_pk_mul_f32 v[192:193], v[16:17], s[54:55] op_sel_hi:[1,0]
    v_pk_mul_f32 v[194:195], v[18:19], s[54:55] op_sel_hi:[1,0]
    v_pk_mul_f32 v[196:197], v[20:21], s[54:55] op_sel_hi:[1,0]
    v_pk_mul_f32 v[198:199], v[22:23], s[54:55] op_sel_hi:[1,0]
    v_exp_f32 v192, v192
    v_exp_f32 v193, v193
    v_mfma_f32_32x32x16_bf16 v[96:111], v[120:123], a[132:135], v[96:111]
    ds_read_b64_tr_b16 v[152:153], v223 offset:28672
    ds_read_b64_tr_b16 v[154:155], v223 offset:28928
    s_add_u32 m0, s46, 133120
    s_lshl4_add_u32 s48, s64, 16384
    buffer_load_dwordx4 v233, s[16:19], s48 offen lds
    v_exp_f32 v194, v194
    v_exp_f32 v195, v195
    v_exp_f32 v196, v196
    v_exp_f32 v197, v197
    v_exp_f32 v198, v198
    v_exp_f32 v199, v199
    v_pk_add_f32 v[192:193], v[192:193], 1.0 op_sel_hi:[1,0]
    v_pk_add_f32 v[194:195], v[194:195], 1.0 op_sel_hi:[1,0]
    v_pk_add_f32 v[196:197], v[196:197], 1.0 op_sel_hi:[1,0]
    v_pk_add_f32 v[198:199], v[198:199], 1.0 op_sel_hi:[1,0]
    v_rcp_f32 v192, v192
    v_rcp_f32 v193, v193
    s_waitcnt lgkmcnt(6)
    v_mfma_f32_32x32x16_bf16 v[64:79], v[128:131], a[136:139], v[64:79]
    ds_read_b64_tr_b16 v[112:113], v219 offset:2048
    ds_read_b64_tr_b16 v[114:115], v219 offset:2560
    buffer_load_dwordx4 v234, s[16:19], s48 offen offset:1024 lds
    v_rcp_f32 v194, v194
    v_rcp_f32 v195, v195
    v_rcp_f32 v196, v196
    v_rcp_f32 v197, v197
    v_rcp_f32 v198, v198
    v_rcp_f32 v199, v199
    v_pk_mul_f32 v[16:17], v[16:17], v[192:193]
    v_pk_mul_f32 v[18:19], v[18:19], v[194:195]
    v_pk_mul_f32 v[20:21], v[20:21], v[196:197]
    v_pk_mul_f32 v[22:23], v[22:23], v[198:199]
    v_cvt_pk_bf16_f32 v16, v16, v17
    v_cvt_pk_bf16_f32 v17, v18, v19
    v_cvt_pk_bf16_f32 v18, v20, v21
    v_cvt_pk_bf16_f32 v19, v22, v23
    v_mfma_f32_32x32x16_bf16 v[80:95], v[132:135], a[136:139], v[80:95]
    ds_read_b64_tr_b16 v[116:117], v220 offset:2048
    ds_read_b64_tr_b16 v[118:119], v220 offset:2560
    s_add_u32 m0, s46, 135168
    s_lshl4_add_u32 s48, s64, 32768
    buffer_load_dwordx4 v233, s[16:19], s48 offen lds
    buffer_store_dwordx4 v[16:19], v244, s[24:27], s57 offen offset:2048 sc1
    v_pk_mul_f32 v[200:201], v[24:25], s[54:55] op_sel_hi:[1,0]
    v_pk_mul_f32 v[202:203], v[26:27], s[54:55] op_sel_hi:[1,0]
    v_pk_mul_f32 v[204:205], v[28:29], s[54:55] op_sel_hi:[1,0]
    v_pk_mul_f32 v[206:207], v[30:31], s[54:55] op_sel_hi:[1,0]
    v_exp_f32 v200, v200
    v_exp_f32 v201, v201
    v_exp_f32 v202, v202
    v_exp_f32 v203, v203
    v_exp_f32 v204, v204
    v_exp_f32 v205, v205
    v_exp_f32 v206, v206
    v_exp_f32 v207, v207
    v_mfma_f32_32x32x16_bf16 v[96:111], v[136:139], a[136:139], v[96:111]
    ds_read_b64_tr_b16 v[120:121], v223 offset:5120
    ds_read_b64_tr_b16 v[122:123], v223 offset:5376
    buffer_load_dwordx4 v234, s[16:19], s48 offen offset:1024 lds
    v_pk_add_f32 v[200:201], v[200:201], 1.0 op_sel_hi:[1,0]
    v_pk_add_f32 v[202:203], v[202:203], 1.0 op_sel_hi:[1,0]
    v_pk_add_f32 v[204:205], v[204:205], 1.0 op_sel_hi:[1,0]
    v_pk_add_f32 v[206:207], v[206:207], 1.0 op_sel_hi:[1,0]
    v_rcp_f32 v200, v200
    v_rcp_f32 v201, v201
    v_rcp_f32 v202, v202
    v_rcp_f32 v203, v203
    v_rcp_f32 v204, v204
    v_rcp_f32 v205, v205
    v_rcp_f32 v206, v206
    v_rcp_f32 v207, v207
    s_waitcnt lgkmcnt(6)
    v_mfma_f32_32x32x16_bf16 v[64:79], v[144:147], a[140:143], v[64:79]
    ds_read_b64_tr_b16 v[128:129], v219 offset:10240
    ds_read_b64_tr_b16 v[130:131], v219 offset:10752
    s_add_u32 m0, s46, 137216
    s_lshl4_add_u32 s48, s64, 49152
    buffer_load_dwordx4 v233, s[16:19], s48 offen lds
    v_pk_mul_f32 v[24:25], v[24:25], v[200:201]
    v_pk_mul_f32 v[26:27], v[26:27], v[202:203]
    v_pk_mul_f32 v[28:29], v[28:29], v[204:205]
    v_pk_mul_f32 v[30:31], v[30:31], v[206:207]
    v_cvt_pk_bf16_f32 v24, v24, v25
    v_cvt_pk_bf16_f32 v25, v26, v27
    v_cvt_pk_bf16_f32 v26, v28, v29
    v_cvt_pk_bf16_f32 v27, v30, v31
    buffer_store_dwordx4 v[24:27], v244, s[24:27], s57 offen offset:3072 sc1
    v_pk_mul_f32 v[192:193], v[32:33], s[54:55] op_sel_hi:[1,0]
    v_pk_mul_f32 v[194:195], v[34:35], s[54:55] op_sel_hi:[1,0]
    v_pk_mul_f32 v[196:197], v[36:37], s[54:55] op_sel_hi:[1,0]
    v_pk_mul_f32 v[198:199], v[38:39], s[54:55] op_sel_hi:[1,0]
    v_exp_f32 v192, v192
    v_exp_f32 v193, v193
    v_exp_f32 v194, v194
    v_exp_f32 v195, v195
    v_mfma_f32_32x32x16_bf16 v[80:95], v[148:151], a[140:143], v[80:95]
    ds_read_b64_tr_b16 v[132:133], v220 offset:10240
    ds_read_b64_tr_b16 v[134:135], v220 offset:10752
    buffer_load_dwordx4 v234, s[16:19], s48 offen offset:1024 lds
    v_exp_f32 v196, v196
    v_exp_f32 v197, v197
    v_exp_f32 v198, v198
    v_exp_f32 v199, v199
    v_pk_add_f32 v[192:193], v[192:193], 1.0 op_sel_hi:[1,0]
    v_pk_add_f32 v[194:195], v[194:195], 1.0 op_sel_hi:[1,0]
    v_pk_add_f32 v[196:197], v[196:197], 1.0 op_sel_hi:[1,0]
    v_pk_add_f32 v[198:199], v[198:199], 1.0 op_sel_hi:[1,0]
    v_rcp_f32 v192, v192
    v_rcp_f32 v193, v193
    v_rcp_f32 v194, v194
    v_rcp_f32 v195, v195
    v_mfma_f32_32x32x16_bf16 v[96:111], v[152:155], a[140:143], v[96:111]
    ds_read_b64_tr_b16 v[136:137], v223 offset:13312
    ds_read_b64_tr_b16 v[138:139], v223 offset:13568
    s_add_u32 m0, s46, 6144
    s_lshl4_add_u32 s48, s65, 0
    buffer_load_dwordx4 v233, s[16:19], s48 offen lds
    v_rcp_f32 v196, v196
    v_rcp_f32 v197, v197
    v_rcp_f32 v198, v198
    v_rcp_f32 v199, v199
    v_pk_mul_f32 v[32:33], v[32:33], v[192:193]
    v_pk_mul_f32 v[34:35], v[34:35], v[194:195]
    v_pk_mul_f32 v[36:37], v[36:37], v[196:197]
    v_pk_mul_f32 v[38:39], v[38:39], v[198:199]
    v_cvt_pk_bf16_f32 v32, v32, v33
    v_cvt_pk_bf16_f32 v33, v34, v35
    v_cvt_pk_bf16_f32 v34, v36, v37
    v_cvt_pk_bf16_f32 v35, v38, v39
    buffer_store_dwordx4 v[32:35], v244, s[24:27], s58 offen offset:0 sc1
    v_pk_mul_f32 v[200:201], v[40:41], s[54:55] op_sel_hi:[1,0]
    v_pk_mul_f32 v[202:203], v[42:43], s[54:55] op_sel_hi:[1,0]
    v_pk_mul_f32 v[204:205], v[44:45], s[54:55] op_sel_hi:[1,0]
    s_waitcnt lgkmcnt(6)
    v_mfma_f32_32x32x16_bf16 v[64:79], v[112:115], a[144:147], v[64:79]
    ds_read_b64_tr_b16 v[144:145], v219 offset:18432
    ds_read_b64_tr_b16 v[146:147], v219 offset:18944
    buffer_load_dwordx4 v234, s[16:19], s48 offen offset:1024 lds
    v_pk_mul_f32 v[206:207], v[46:47], s[54:55] op_sel_hi:[1,0]
    v_exp_f32 v200, v200
    v_exp_f32 v201, v201
    v_exp_f32 v202, v202
    v_exp_f32 v203, v203
    v_exp_f32 v204, v204
    v_exp_f32 v205, v205
    v_exp_f32 v206, v206
    v_exp_f32 v207, v207
    v_pk_add_f32 v[200:201], v[200:201], 1.0 op_sel_hi:[1,0]
    v_pk_add_f32 v[202:203], v[202:203], 1.0 op_sel_hi:[1,0]
    v_pk_add_f32 v[204:205], v[204:205], 1.0 op_sel_hi:[1,0]
    v_mfma_f32_32x32x16_bf16 v[80:95], v[116:119], a[144:147], v[80:95]
    ds_read_b64_tr_b16 v[148:149], v220 offset:18432
    ds_read_b64_tr_b16 v[150:151], v220 offset:18944
    s_add_u32 m0, s46, 38912
    s_lshl4_add_u32 s48, s65, 16384
    buffer_load_dwordx4 v233, s[16:19], s48 offen lds
    v_pk_add_f32 v[206:207], v[206:207], 1.0 op_sel_hi:[1,0]
    v_rcp_f32 v200, v200
    v_rcp_f32 v201, v201
    v_rcp_f32 v202, v202
    v_rcp_f32 v203, v203
    v_rcp_f32 v204, v204
    v_rcp_f32 v205, v205
    v_rcp_f32 v206, v206
    v_rcp_f32 v207, v207
    v_pk_mul_f32 v[40:41], v[40:41], v[200:201]
    v_pk_mul_f32 v[42:43], v[42:43], v[202:203]
    v_pk_mul_f32 v[44:45], v[44:45], v[204:205]
    v_mfma_f32_32x32x16_bf16 v[96:111], v[120:123], a[144:147], v[96:111]
    ds_read_b64_tr_b16 v[152:153], v223 offset:21504
    ds_read_b64_tr_b16 v[154:155], v223 offset:21760
    buffer_load_dwordx4 v234, s[16:19], s48 offen offset:1024 lds
    v_pk_mul_f32 v[46:47], v[46:47], v[206:207]
    v_cvt_pk_bf16_f32 v40, v40, v41
    v_cvt_pk_bf16_f32 v41, v42, v43
    v_cvt_pk_bf16_f32 v42, v44, v45
    v_cvt_pk_bf16_f32 v43, v46, v47
    buffer_store_dwordx4 v[40:43], v244, s[24:27], s58 offen offset:1024 sc1
    v_pk_mul_f32 v[192:193], v[48:49], s[54:55] op_sel_hi:[1,0]
    v_pk_mul_f32 v[194:195], v[50:51], s[54:55] op_sel_hi:[1,0]
    v_pk_mul_f32 v[196:197], v[52:53], s[54:55] op_sel_hi:[1,0]
    v_pk_mul_f32 v[198:199], v[54:55], s[54:55] op_sel_hi:[1,0]
    v_exp_f32 v192, v192
    v_exp_f32 v193, v193
    v_exp_f32 v194, v194
    v_exp_f32 v195, v195
    v_exp_f32 v196, v196
    s_waitcnt lgkmcnt(6)
    v_mfma_f32_32x32x16_bf16 v[64:79], v[128:131], a[148:151], v[64:79]
    ds_read_b64_tr_b16 v[112:113], v219 offset:26624
    ds_read_b64_tr_b16 v[114:115], v219 offset:27136
    s_add_u32 m0, s46, 71680
    s_lshl4_add_u32 s48, s65, 32768
    buffer_load_dwordx4 v233, s[16:19], s48 offen lds
    v_exp_f32 v197, v197
    v_exp_f32 v198, v198
    v_exp_f32 v199, v199
    v_pk_add_f32 v[192:193], v[192:193], 1.0 op_sel_hi:[1,0]
    v_pk_add_f32 v[194:195], v[194:195], 1.0 op_sel_hi:[1,0]
    v_pk_add_f32 v[196:197], v[196:197], 1.0 op_sel_hi:[1,0]
    v_pk_add_f32 v[198:199], v[198:199], 1.0 op_sel_hi:[1,0]
    v_rcp_f32 v192, v192
    v_rcp_f32 v193, v193
    v_rcp_f32 v194, v194
    v_rcp_f32 v195, v195
    v_rcp_f32 v196, v196
    v_mfma_f32_32x32x16_bf16 v[80:95], v[132:135], a[148:151], v[80:95]
    ds_read_b64_tr_b16 v[116:117], v220 offset:26624
    ds_read_b64_tr_b16 v[118:119], v220 offset:27136
    buffer_load_dwordx4 v234, s[16:19], s48 offen offset:1024 lds
    v_rcp_f32 v197, v197
    v_rcp_f32 v198, v198
    v_rcp_f32 v199, v199
    v_pk_mul_f32 v[48:49], v[48:49], v[192:193]
    v_pk_mul_f32 v[50:51], v[50:51], v[194:195]
    v_pk_mul_f32 v[52:53], v[52:53], v[196:197]
    v_pk_mul_f32 v[54:55], v[54:55], v[198:199]
    v_cvt_pk_bf16_f32 v48, v48, v49
    v_cvt_pk_bf16_f32 v49, v50, v51
    v_cvt_pk_bf16_f32 v50, v52, v53
    v_cvt_pk_bf16_f32 v51, v54, v55
    buffer_store_dwordx4 v[48:51], v244, s[24:27], s58 offen offset:2048 sc1
    v_pk_mul_f32 v[200:201], v[56:57], s[54:55] op_sel_hi:[1,0]
    v_pk_mul_f32 v[202:203], v[58:59], s[54:55] op_sel_hi:[1,0]
    v_pk_mul_f32 v[204:205], v[60:61], s[54:55] op_sel_hi:[1,0]
    v_pk_mul_f32 v[206:207], v[62:63], s[54:55] op_sel_hi:[1,0]
    v_exp_f32 v200, v200
    v_mfma_f32_32x32x16_bf16 v[96:111], v[136:139], a[148:151], v[96:111]
    ds_read_b64_tr_b16 v[120:121], v223 offset:29696
    ds_read_b64_tr_b16 v[122:123], v223 offset:29952
    s_add_u32 m0, s46, 104448
    s_lshl4_add_u32 s48, s65, 49152
    buffer_load_dwordx4 v233, s[16:19], s48 offen lds
    v_exp_f32 v201, v201
    v_exp_f32 v202, v202
    v_exp_f32 v203, v203
    v_exp_f32 v204, v204
    v_exp_f32 v205, v205
    v_exp_f32 v206, v206
    v_exp_f32 v207, v207
    v_pk_add_f32 v[200:201], v[200:201], 1.0 op_sel_hi:[1,0]
    v_pk_add_f32 v[202:203], v[202:203], 1.0 op_sel_hi:[1,0]
    v_pk_add_f32 v[204:205], v[204:205], 1.0 op_sel_hi:[1,0]
    v_pk_add_f32 v[206:207], v[206:207], 1.0 op_sel_hi:[1,0]
    v_rcp_f32 v200, v200
    s_waitcnt lgkmcnt(6)
    v_mfma_f32_32x32x16_bf16 v[64:79], v[144:147], a[152:155], v[64:79]
    s_waitcnt lgkmcnt(0) vmcnt(34)
    s_barrier
    ds_read_b64_tr_b16 v[128:129], v219 offset:32768
    ds_read_b64_tr_b16 v[130:131], v219 offset:33280
    buffer_load_dwordx4 v234, s[16:19], s48 offen offset:1024 lds
    v_rcp_f32 v201, v201
    v_rcp_f32 v202, v202
    v_rcp_f32 v203, v203
    v_rcp_f32 v204, v204
    v_rcp_f32 v205, v205
    v_rcp_f32 v206, v206
    v_rcp_f32 v207, v207
    v_pk_mul_f32 v[56:57], v[56:57], v[200:201]
    v_pk_mul_f32 v[58:59], v[58:59], v[202:203]
    v_pk_mul_f32 v[60:61], v[60:61], v[204:205]
    v_pk_mul_f32 v[62:63], v[62:63], v[206:207]
    v_cvt_pk_bf16_f32 v56, v56, v57
    v_cvt_pk_bf16_f32 v57, v58, v59
    v_mfma_f32_32x32x16_bf16 v[80:95], v[148:151], a[152:155], v[80:95]
    ds_read_b64_tr_b16 v[132:133], v220 offset:32768
    ds_read_b64_tr_b16 v[134:135], v220 offset:33280
    s_add_u32 m0, s46, 0
    s_lshl4_add_u32 s48, s66, 0
    buffer_load_dwordx4 v233, s[16:19], s48 offen lds
    v_cvt_pk_bf16_f32 v58, v60, v61
    v_cvt_pk_bf16_f32 v59, v62, v63
    buffer_store_dwordx4 v[56:59], v244, s[24:27], s58 offen offset:3072 sc1
    v_mfma_f32_32x32x16_bf16 v[96:111], v[152:155], a[152:155], v[96:111]
    ds_read_b64_tr_b16 v[136:137], v223 offset:36864
    ds_read_b64_tr_b16 v[138:139], v223 offset:37120
    v_mfma_f32_32x32x16_bf16 v[64:79], v[112:115], a[156:159], v[64:79]
    ds_read_b64_tr_b16 v[144:145], v219 offset:40960
    ds_read_b64_tr_b16 v[146:147], v219 offset:41472
    v_mfma_f32_32x32x16_bf16 v[80:95], v[116:119], a[156:159], v[80:95]
    ds_read_b64_tr_b16 v[148:149], v220 offset:40960
    ds_read_b64_tr_b16 v[150:151], v220 offset:41472
    buffer_load_dwordx4 v234, s[16:19], s48 offen offset:1024 lds
    v_mfma_f32_32x32x16_bf16 v[96:111], v[120:123], a[156:159], v[96:111]
    ds_read_b64_tr_b16 v[152:153], v223 offset:45056
    ds_read_b64_tr_b16 v[154:155], v223 offset:45312
    s_waitcnt lgkmcnt(6)
    v_mfma_f32_32x32x16_bf16 v[64:79], v[128:131], a[160:163], v[64:79]
    ds_read_b64_tr_b16 v[112:113], v219 offset:49152
    ds_read_b64_tr_b16 v[114:115], v219 offset:49664
    v_mfma_f32_32x32x16_bf16 v[80:95], v[132:135], a[160:163], v[80:95]
    ds_read_b64_tr_b16 v[116:117], v220 offset:49152
    ds_read_b64_tr_b16 v[118:119], v220 offset:49664
    s_add_u32 m0, s46, 2048
    s_lshl4_add_u32 s48, s66, 16384
    buffer_load_dwordx4 v233, s[16:19], s48 offen lds
    v_mfma_f32_32x32x16_bf16 v[96:111], v[136:139], a[160:163], v[96:111]
    ds_read_b64_tr_b16 v[120:121], v223 offset:53248
    ds_read_b64_tr_b16 v[122:123], v223 offset:53504
    s_waitcnt lgkmcnt(6)
    v_mfma_f32_32x32x16_bf16 v[64:79], v[144:147], a[164:167], v[64:79]
    ds_read_b64_tr_b16 v[128:129], v219 offset:57344
    ds_read_b64_tr_b16 v[130:131], v219 offset:57856
    buffer_load_dwordx4 v234, s[16:19], s48 offen offset:1024 lds
    v_mfma_f32_32x32x16_bf16 v[80:95], v[148:151], a[164:167], v[80:95]
    ds_read_b64_tr_b16 v[132:133], v220 offset:57344
    ds_read_b64_tr_b16 v[134:135], v220 offset:57856
    v_mfma_f32_32x32x16_bf16 v[96:111], v[152:155], a[164:167], v[96:111]
    ds_read_b64_tr_b16 v[136:137], v223 offset:61440
    ds_read_b64_tr_b16 v[138:139], v223 offset:61696
    s_waitcnt lgkmcnt(6)
    v_mfma_f32_32x32x16_bf16 v[64:79], v[112:115], a[168:171], v[64:79]
    ds_read_b64_tr_b16 v[144:145], v219 offset:34816
    ds_read_b64_tr_b16 v[146:147], v219 offset:35328
    s_add_u32 m0, s46, 4096
    s_lshl4_add_u32 s48, s66, 32768
    buffer_load_dwordx4 v233, s[16:19], s48 offen lds
    v_mfma_f32_32x32x16_bf16 v[80:95], v[116:119], a[168:171], v[80:95]
    ds_read_b64_tr_b16 v[148:149], v220 offset:34816
    ds_read_b64_tr_b16 v[150:151], v220 offset:35328
    buffer_load_dwordx4 v234, s[16:19], s48 offen offset:1024 lds
    v_mfma_f32_32x32x16_bf16 v[96:111], v[120:123], a[168:171], v[96:111]
    ds_read_b64_tr_b16 v[152:153], v223 offset:37888
    ds_read_b64_tr_b16 v[154:155], v223 offset:38144
    s_waitcnt lgkmcnt(6)
    v_mfma_f32_32x32x16_bf16 v[64:79], v[128:131], a[172:175], v[64:79]
    ds_read_b64_tr_b16 v[112:113], v219 offset:43008
    ds_read_b64_tr_b16 v[114:115], v219 offset:43520
    v_mfma_f32_32x32x16_bf16 v[80:95], v[132:135], a[172:175], v[80:95]
    ds_read_b64_tr_b16 v[116:117], v220 offset:43008
    ds_read_b64_tr_b16 v[118:119], v220 offset:43520
    v_mfma_f32_32x32x16_bf16 v[96:111], v[136:139], a[172:175], v[96:111]
    ds_read_b64_tr_b16 v[120:121], v223 offset:46080
    ds_read_b64_tr_b16 v[122:123], v223 offset:46336
    s_waitcnt vmcnt(27)
    ds_read_b64_tr_b16 a[0:1], v239 offset:0
    ds_read_b64_tr_b16 a[4:5], v240 offset:0
    ds_read_b64_tr_b16 a[2:3], v239 offset:1024
    ds_read_b64_tr_b16 a[6:7], v240 offset:1024
    s_waitcnt lgkmcnt(0)
    s_add_u32 m0, s46, 131072
    s_lshl4_add_u32 s48, s66, 49152
    buffer_load_dwordx4 v233, s[16:19], s48 offen lds
    v_mfma_f32_32x32x16_bf16 v[64:79], v[144:147], a[176:179], v[64:79]
    ds_read_b64_tr_b16 v[128:129], v219 offset:51200
    ds_read_b64_tr_b16 v[130:131], v219 offset:51712
    buffer_load_dwordx4 v234, s[16:19], s48 offen offset:1024 lds
    v_mfma_f32_32x32x16_bf16 v[80:95], v[148:151], a[176:179], v[80:95]
    ds_read_b64_tr_b16 v[132:133], v220 offset:51200
    ds_read_b64_tr_b16 v[134:135], v220 offset:51712
    v_mfma_f32_32x32x16_bf16 v[96:111], v[152:155], a[176:179], v[96:111]
    ds_read_b64_tr_b16 v[136:137], v223 offset:54272
    ds_read_b64_tr_b16 v[138:139], v223 offset:54528
    v_mfma_f32_32x32x16_bf16 v[64:79], v[112:115], a[180:183], v[64:79]
    ds_read_b64_tr_b16 v[144:145], v219 offset:59392
    ds_read_b64_tr_b16 v[146:147], v219 offset:59904
    v_mfma_f32_32x32x16_bf16 v[80:95], v[116:119], a[180:183], v[80:95]
    ds_read_b64_tr_b16 v[148:149], v220 offset:59392
    ds_read_b64_tr_b16 v[150:151], v220 offset:59904
    s_waitcnt vmcnt(26)
    ds_read_b64_tr_b16 a[8:9], v239 offset:2048
    ds_read_b64_tr_b16 a[12:13], v240 offset:2048
    ds_read_b64_tr_b16 a[10:11], v239 offset:3072
    ds_read_b64_tr_b16 a[14:15], v240 offset:3072
    s_waitcnt lgkmcnt(0)
    s_add_u32 m0, s46, 133120
    s_lshl4_add_u32 s48, s67, 0
    buffer_load_dwordx4 v233, s[16:19], s48 offen lds
    v_mfma_f32_32x32x16_bf16 v[96:111], v[120:123], a[180:183], v[96:111]
    ds_read_b64_tr_b16 v[152:153], v223 offset:62464
    ds_read_b64_tr_b16 v[154:155], v223 offset:62720
    buffer_load_dwordx4 v234, s[16:19], s48 offen offset:1024 lds
    v_mfma_f32_32x32x16_bf16 v[64:79], v[128:131], a[184:187], v[64:79]
    s_waitcnt lgkmcnt(0)
    s_barrier
    ds_read_b64_tr_b16 v[112:113], v221 offset:0
    ds_read_b64_tr_b16 v[114:115], v221 offset:512
    ds_read_b64_tr_b16 v[116:117], v221 offset:8192
    s_add_u32 m0, s46, 32768
    s_lshl4_add_u32 s48, s67, 16384
    buffer_load_dwordx4 v233, s[16:19], s48 offen lds
    v_mfma_f32_32x32x16_bf16 v[80:95], v[132:135], a[184:187], v[80:95]
    ds_read_b64_tr_b16 v[118:119], v221 offset:8704
    ds_read_b64_tr_b16 v[120:121], v221 offset:16384
    ds_read_b64_tr_b16 v[122:123], v221 offset:16896
    buffer_load_dwordx4 v234, s[16:19], s48 offen offset:1024 lds
    v_mfma_f32_32x32x16_bf16 v[96:111], v[136:139], a[184:187], v[96:111]
    ds_read_b64_tr_b16 v[124:125], v221 offset:24576
    ds_read_b64_tr_b16 v[126:127], v221 offset:25088
    s_waitcnt vmcnt(27)
    ds_read_b64_tr_b16 a[16:17], v239 offset:4096
    ds_read_b64_tr_b16 a[20:21], v240 offset:4096
    ds_read_b64_tr_b16 a[18:19], v239 offset:5120
    ds_read_b64_tr_b16 a[22:23], v240 offset:5120
    v_mfma_f32_32x32x16_bf16 v[64:79], v[144:147], a[188:191], v[64:79]
    ds_read_b64_tr_b16 v[128:129], v221 offset:2048
    ds_read_b64_tr_b16 v[130:131], v221 offset:2560
    ds_read_b64_tr_b16 v[132:133], v221 offset:10240
    v_mfma_f32_32x32x16_bf16 v[80:95], v[148:151], a[188:191], v[80:95]
    ds_read_b64_tr_b16 v[134:135], v221 offset:10752
    ds_read_b64_tr_b16 v[136:137], v221 offset:18432
    ds_read_b64_tr_b16 v[138:139], v221 offset:18944
    v_mfma_f32_32x32x16_bf16 v[96:111], v[152:155], a[188:191], v[96:111]
    ds_read_b64_tr_b16 v[140:141], v221 offset:26624
    ds_read_b64_tr_b16 v[142:143], v221 offset:27136
    s_add_u32 m0, s46, 34816
    s_lshl4_add_u32 s48, s67, 32768
    buffer_load_dwordx4 v233, s[16:19], s48 offen lds
    s_waitcnt lgkmcnt(12)
    v_mfma_f32_32x32x16_bf16 v[64:79], v[112:115], a[192:195], v[64:79]
    s_waitcnt lgkmcnt(0)
    s_barrier
    ds_read_b64_tr_b16 v[144:145], v221 offset:32768
    ds_read_b64_tr_b16 v[146:147], v221 offset:33280
    buffer_load_dwordx4 v234, s[16:19], s48 offen offset:1024 lds
    s_waitcnt vmcnt(26)
    ds_read_b64_tr_b16 a[24:25], v239 offset:6144
    ds_read_b64_tr_b16 a[28:29], v240 offset:6144
    ds_read_b64_tr_b16 a[26:27], v239 offset:7168
    ds_read_b64_tr_b16 a[30:31], v240 offset:7168
    v_mfma_f32_32x32x16_bf16 v[64:79], v[116:119], a[196:199], v[64:79]
    ds_read_b64_tr_b16 v[148:149], v221 offset:40960
    ds_read_b64_tr_b16 v[150:151], v221 offset:41472
    v_mfma_f32_32x32x16_bf16 v[64:79], v[120:123], a[200:203], v[64:79]
    ds_read_b64_tr_b16 v[152:153], v221 offset:49152
    ds_read_b64_tr_b16 v[154:155], v221 offset:49664
    s_add_u32 m0, s46, 36864
    s_lshl4_add_u32 s48, s67, 49152
    buffer_load_dwordx4 v233, s[16:19], s48 offen lds
    v_mfma_f32_32x32x16_bf16 v[64:79], v[124:127], a[204:207], v[64:79]
    ds_read_b64_tr_b16 v[156:157], v221 offset:57344
    ds_read_b64_tr_b16 v[158:159], v221 offset:57856
    buffer_load_dwordx4 v234, s[16:19], s48 offen offset:1024 lds
    v_mfma_f32_32x32x16_bf16 v[64:79], v[128:131], a[208:211], v[64:79]
    ds_read_b64_tr_b16 v[112:113], v221 offset:34816
    ds_read_b64_tr_b16 v[114:115], v221 offset:35328
    v_mfma_f32_32x32x16_bf16 v[64:79], v[132:135], a[212:215], v[64:79]
    ds_read_b64_tr_b16 v[116:117], v221 offset:43008
    ds_read_b64_tr_b16 v[118:119], v221 offset:43520
    v_mfma_f32_32x32x16_bf16 v[64:79], v[136:139], a[216:219], v[64:79]
    ds_read_b64_tr_b16 v[120:121], v221 offset:51200
    ds_read_b64_tr_b16 v[122:123], v221 offset:51712
    v_mfma_f32_32x32x16_bf16 v[64:79], v[140:143], a[220:223], v[64:79]
    ds_read_b64_tr_b16 v[124:125], v221 offset:59392
    ds_read_b64_tr_b16 v[126:127], v221 offset:59904
    s_add_u32 m0, s46, 135168
    s_lshl4_add_u32 s48, s68, 0
    buffer_load_dwordx4 v233, s[16:19], s48 offen lds
    s_waitcnt vmcnt(26)
    ds_read_b64_tr_b16 a[32:33], v235 offset:6144
    ds_read_b64_tr_b16 a[36:37], v236 offset:6144
    ds_read_b64_tr_b16 a[34:35], v235 offset:7168
    ds_read_b64_tr_b16 a[38:39], v236 offset:7168
    s_waitcnt lgkmcnt(12)
    v_mfma_f32_32x32x16_bf16 v[64:79], v[144:147], a[224:227], v[64:79]
    ds_read_b64_tr_b16 v[128:129], v222 offset:0
    ds_read_b64_tr_b16 v[130:131], v222 offset:512
    buffer_load_dwordx4 v234, s[16:19], s48 offen offset:1024 lds
    s_waitcnt vmcnt(25)
    ds_read_b64_tr_b16 a[40:41], v235 offset:38912
    ds_read_b64_tr_b16 a[44:45], v236 offset:38912
    ds_read_b64_tr_b16 a[42:43], v235 offset:39936
    ds_read_b64_tr_b16 a[46:47], v236 offset:39936
    v_mfma_f32_32x32x16_bf16 v[64:79], v[148:151], a[228:231], v[64:79]
    ds_read_b64_tr_b16 v[132:133], v222 offset:8192
    ds_read_b64_tr_b16 v[134:135], v222 offset:8704
    v_mfma_f32_32x32x16_bf16 v[64:79], v[152:155], a[232:235], v[64:79]
    ds_read_b64_tr_b16 v[136:137], v222 offset:16384
    ds_read_b64_tr_b16 v[138:139], v222 offset:16896
    v_mfma_f32_32x32x16_bf16 v[64:79], v[156:159], a[236:239], v[64:79]
    ds_read_b64_tr_b16 v[140:141], v222 offset:24576
    ds_read_b64_tr_b16 v[142:143], v222 offset:25088
    s_waitcnt lgkmcnt(15)
    v_mfma_f32_32x32x16_bf16 v[64:79], v[112:115], a[240:243], v[64:79]
    ds_read_b64_tr_b16 v[144:145], v222 offset:2048
    ds_read_b64_tr_b16 v[146:147], v222 offset:2560
    s_add_u32 m0, s46, 137216
    s_lshl4_add_u32 s48, s68, 16384
    buffer_load_dwordx4 v233, s[16:19], s48 offen lds
    v_mfma_f32_32x32x16_bf16 v[64:79], v[116:119], a[244:247], v[64:79]
    ds_read_b64_tr_b16 v[148:149], v222 offset:10240
    ds_read_b64_tr_b16 v[150:151], v222 offset:10752
    buffer_load_dwordx4 v234, s[16:19], s48 offen offset:1024 lds
    v_mfma_f32_32x32x16_bf16 v[64:79], v[120:123], a[248:251], v[64:79]
    ds_read_b64_tr_b16 v[152:153], v222 offset:18432
    ds_read_b64_tr_b16 v[154:155], v222 offset:18944
    v_mfma_f32_32x32x16_bf16 v[64:79], v[124:127], a[252:255], v[64:79]
    ds_read_b64_tr_b16 v[156:157], v222 offset:26624
    ds_read_b64_tr_b16 v[158:159], v222 offset:27136
    s_waitcnt lgkmcnt(8)
    v_mfma_f32_32x32x16_bf16 v[80:95], v[128:131], a[192:195], v[80:95]
    ds_read_b64_tr_b16 v[112:113], v222 offset:32768
    ds_read_b64_tr_b16 v[114:115], v222 offset:33280
    s_waitcnt vmcnt(24)
    ds_read_b64_tr_b16 a[48:49], v237 offset:6144
    ds_read_b64_tr_b16 a[52:53], v238 offset:6144
    ds_read_b64_tr_b16 a[50:51], v237 offset:7168
    ds_read_b64_tr_b16 a[54:55], v238 offset:7168
    s_nop 0
    v_pk_mul_f32 v[192:193], v[64:65], s[54:55] op_sel_hi:[1,0]
    v_pk_mul_f32 v[194:195], v[66:67], s[54:55] op_sel_hi:[1,0]
    s_add_u32 m0, s46, 6144
    s_lshl4_add_u32 s48, s68, 32768
    buffer_load_dwordx4 v233, s[16:19], s48 offen lds
    v_pk_mul_f32 v[196:197], v[68:69], s[54:55] op_sel_hi:[1,0]
    v_pk_mul_f32 v[198:199], v[70:71], s[54:55] op_sel_hi:[1,0]
    v_exp_f32 v192, v192
    v_exp_f32 v193, v193
    v_exp_f32 v194, v194
    v_exp_f32 v195, v195
    v_exp_f32 v196, v196
    v_exp_f32 v197, v197
    v_exp_f32 v198, v198
    v_exp_f32 v199, v199
    s_waitcnt vmcnt(20)
    buffer_store_dword v230, v245, s[24:27], 0 offen sc1
    v_mfma_f32_32x32x16_bf16 v[80:95], v[132:135], a[196:199], v[80:95]
    ds_read_b64_tr_b16 v[116:117], v222 offset:40960
    ds_read_b64_tr_b16 v[118:119], v222 offset:41472
    buffer_load_dwordx4 v234, s[16:19], s48 offen offset:1024 lds
    v_pk_add_f32 v[192:193], v[192:193], 1.0 op_sel_hi:[1,0]
    v_pk_add_f32 v[194:195], v[194:195], 1.0 op_sel_hi:[1,0]
    v_pk_add_f32 v[196:197], v[196:197], 1.0 op_sel_hi:[1,0]
    v_pk_add_f32 v[198:199], v[198:199], 1.0 op_sel_hi:[1,0]
    v_rcp_f32 v192, v192
    v_rcp_f32 v193, v193
    v_rcp_f32 v194, v194
    v_rcp_f32 v195, v195
    v_rcp_f32 v196, v196
    ds_read_b64_tr_b16 a[56:57], v237 offset:38912
    ds_read_b64_tr_b16 a[60:61], v238 offset:38912
    ds_read_b64_tr_b16 a[58:59], v237 offset:39936
    ds_read_b64_tr_b16 a[62:63], v238 offset:39936
    v_rcp_f32 v197, v197
    v_rcp_f32 v198, v198
    v_rcp_f32 v199, v199
    v_mfma_f32_32x32x16_bf16 v[80:95], v[136:139], a[200:203], v[80:95]
    ds_read_b64_tr_b16 v[120:121], v222 offset:49152
    ds_read_b64_tr_b16 v[122:123], v222 offset:49664
    s_add_u32 m0, s46, 38912
    s_lshl4_add_u32 s48, s69, 0
    buffer_load_dwordx4 v233, s[16:19], s48 offen lds
    v_pk_mul_f32 v[64:65], v[64:65], v[192:193]
    v_pk_mul_f32 v[66:67], v[66:67], v[194:195]
    v_pk_mul_f32 v[68:69], v[68:69], v[196:197]
    v_pk_mul_f32 v[70:71], v[70:71], v[198:199]
    v_cvt_pk_bf16_f32 v64, v64, v65
    v_cvt_pk_bf16_f32 v65, v66, v67
    v_cvt_pk_bf16_f32 v66, v68, v69
    v_cvt_pk_bf16_f32 v67, v70, v71
    buffer_store_dwordx4 v[64:67], v244, s[24:27], s59 offen offset:0 sc1
    v_pk_mul_f32 v[200:201], v[72:73], s[54:55] op_sel_hi:[1,0]
    v_pk_mul_f32 v[202:203], v[74:75], s[54:55] op_sel_hi:[1,0]
    v_pk_mul_f32 v[204:205], v[76:77], s[54:55] op_sel_hi:[1,0]
    v_pk_mul_f32 v[206:207], v[78:79], s[54:55] op_sel_hi:[1,0]
    v_exp_f32 v200, v200
    v_exp_f32 v201, v201
    v_exp_f32 v202, v202
    v_exp_f32 v203, v203
    v_mfma_f32_32x32x16_bf16 v[80:95], v[140:143], a[204:207], v[80:95]
    ds_read_b64_tr_b16 v[124:125], v222 offset:57344
    ds_read_b64_tr_b16 v[126:127], v222 offset:57856
    buffer_load_dwordx4 v234, s[16:19], s48 offen offset:1024 lds
    v_exp_f32 v204, v204
    v_exp_f32 v205, v205
    v_exp_f32 v206, v206
    v_exp_f32 v207, v207
    v_pk_add_f32 v[200:201], v[200:201], 1.0 op_sel_hi:[1,0]
    v_pk_add_f32 v[202:203], v[202:203], 1.0 op_sel_hi:[1,0]
    v_pk_add_f32 v[204:205], v[204:205], 1.0 op_sel_hi:[1,0]
    v_pk_add_f32 v[206:207], v[206:207], 1.0 op_sel_hi:[1,0]
    v_rcp_f32 v200, v200
    v_rcp_f32 v201, v201
    v_rcp_f32 v202, v202
    v_rcp_f32 v203, v203
    s_waitcnt lgkmcnt(15)
    v_mfma_f32_32x32x16_bf16 v[80:95], v[144:147], a[208:211], v[80:95]
    ds_read_b64_tr_b16 v[128:129], v222 offset:34816
    ds_read_b64_tr_b16 v[130:131], v222 offset:35328
    s_waitcnt lgkmcnt(12)
    s_add_u32 m0, s46, 71680
    s_lshl4_add_u32 s48, s69, 16384
    buffer_load_dwordx4 v233, s[16:19], s48 offen lds
    v_rcp_f32 v204, v204
    v_rcp_f32 v205, v205
    v_rcp_f32 v206, v206
    v_rcp_f32 v207, v207
    v_pk_mul_f32 v[72:73], v[72:73], v[200:201]
    s_waitcnt vmcnt(25)
    ds_read_b64_tr_b16 a[64:65], v235 offset:0
    ds_read_b64_tr_b16 a[68:69], v236 offset:0
    ds_read_b64_tr_b16 a[66:67], v235 offset:1024
    ds_read_b64_tr_b16 a[70:71], v236 offset:1024
    v_pk_mul_f32 v[74:75], v[74:75], v[202:203]
    v_pk_mul_f32 v[76:77], v[76:77], v[204:205]
    v_pk_mul_f32 v[78:79], v[78:79], v[206:207]
    v_cvt_pk_bf16_f32 v72, v72, v73
    v_cvt_pk_bf16_f32 v73, v74, v75
    v_cvt_pk_bf16_f32 v74, v76, v77
    v_cvt_pk_bf16_f32 v75, v78, v79
    buffer_store_dwordx4 v[72:75], v244, s[24:27], s59 offen offset:1024 sc1
    v_mfma_f32_32x32x16_bf16 v[80:95], v[148:151], a[212:215], v[80:95]
    ds_read_b64_tr_b16 v[132:133], v222 offset:43008
    ds_read_b64_tr_b16 v[134:135], v222 offset:43520
    buffer_load_dwordx4 v234, s[16:19], s48 offen offset:1024 lds
    s_waitcnt vmcnt(25)
    ds_read_b64_tr_b16 a[72:73], v235 offset:2048
    ds_read_b64_tr_b16 a[76:77], v236 offset:2048
    ds_read_b64_tr_b16 a[74:75], v235 offset:3072
    ds_read_b64_tr_b16 a[78:79], v236 offset:3072
    v_mfma_f32_32x32x16_bf16 v[80:95], v[152:155], a[216:219], v[80:95]
    ds_read_b64_tr_b16 v[136:137], v222 offset:51200
    ds_read_b64_tr_b16 v[138:139], v222 offset:51712
    v_mfma_f32_32x32x16_bf16 v[80:95], v[156:159], a[220:223], v[80:95]
    ds_read_b64_tr_b16 v[140:141], v222 offset:59392
    ds_read_b64_tr_b16 v[142:143], v222 offset:59904
    s_waitcnt lgkmcnt(15)
    v_mfma_f32_32x32x16_bf16 v[80:95], v[112:115], a[224:227], v[80:95]
    ds_read_b64_tr_b16 v[144:145], v224 offset:4096
    ds_read_b64_tr_b16 v[146:147], v224 offset:4352
    s_add_u32 m0, s46, 104448
    s_lshl4_add_u32 s48, s69, 32768
    buffer_load_dwordx4 v233, s[16:19], s48 offen lds
    s_waitcnt vmcnt(24)
    ds_read_b64_tr_b16 a[80:81], v235 offset:4096
    ds_read_b64_tr_b16 a[84:85], v236 offset:4096
    ds_read_b64_tr_b16 a[82:83], v235 offset:5120
    ds_read_b64_tr_b16 a[86:87], v236 offset:5120
    v_mfma_f32_32x32x16_bf16 v[80:95], v[116:119], a[228:231], v[80:95]
    ds_read_b64_tr_b16 v[148:149], v224 offset:12288
    ds_read_b64_tr_b16 v[150:151], v224 offset:12544
    buffer_load_dwordx4 v234, s[16:19], s48 offen offset:1024 lds
    v_mfma_f32_32x32x16_bf16 v[80:95], v[120:123], a[232:235], v[80:95]
    ds_read_b64_tr_b16 v[152:153], v224 offset:20480
    ds_read_b64_tr_b16 v[154:155], v224 offset:20736
    v_mfma_f32_32x32x16_bf16 v[80:95], v[124:127], a[236:239], v[80:95]
    ds_read_b64_tr_b16 v[156:157], v224 offset:28672
    ds_read_b64_tr_b16 v[158:159], v224 offset:28928
    s_waitcnt lgkmcnt(12)
    v_mfma_f32_32x32x16_bf16 v[80:95], v[128:131], a[240:243], v[80:95]
    ds_read_b64_tr_b16 v[112:113], v224 offset:5120
    ds_read_b64_tr_b16 v[114:115], v224 offset:5376
    v_mfma_f32_32x32x16_bf16 v[80:95], v[132:135], a[244:247], v[80:95]
    ds_read_b64_tr_b16 v[116:117], v224 offset:13312
    ds_read_b64_tr_b16 v[118:119], v224 offset:13568
    s_add_u32 m0, s46, 0
    s_lshl4_add_u32 s48, s70, 0
    buffer_load_dwordx4 v233, s[16:19], s48 offen lds
    v_mfma_f32_32x32x16_bf16 v[80:95], v[136:139], a[248:251], v[80:95]
    ds_read_b64_tr_b16 v[120:121], v224 offset:21504
    ds_read_b64_tr_b16 v[122:123], v224 offset:21760
    buffer_load_dwordx4 v234, s[16:19], s48 offen offset:1024 lds
    v_mfma_f32_32x32x16_bf16 v[80:95], v[140:143], a[252:255], v[80:95]
    ds_read_b64_tr_b16 v[124:125], v224 offset:29696
    ds_read_b64_tr_b16 v[126:127], v224 offset:29952
    s_waitcnt lgkmcnt(8)
    v_mfma_f32_32x32x16_bf16 v[96:111], v[144:147], a[192:195], v[96:111]
    ds_read_b64_tr_b16 v[128:129], v224 offset:36864
    ds_read_b64_tr_b16 v[130:131], v224 offset:37120
    v_mfma_f32_32x32x16_bf16 v[96:111], v[148:151], a[196:199], v[96:111]
    ds_read_b64_tr_b16 v[132:133], v224 offset:45056
    ds_read_b64_tr_b16 v[134:135], v224 offset:45312
    s_waitcnt vmcnt(25)
    ds_read_b64_tr_b16 a[88:89], v239 offset:0
    ds_read_b64_tr_b16 a[92:93], v240 offset:0
    ds_read_b64_tr_b16 a[90:91], v239 offset:1024
    ds_read_b64_tr_b16 a[94:95], v240 offset:1024
    v_pk_mul_f32 v[192:193], v[80:81], s[54:55] op_sel_hi:[1,0]
    v_pk_mul_f32 v[194:195], v[82:83], s[54:55] op_sel_hi:[1,0]
    s_add_u32 m0, s46, 2048
    s_lshl4_add_u32 s48, s70, 16384
    buffer_load_dwordx4 v233, s[16:19], s48 offen lds
    v_pk_mul_f32 v[196:197], v[84:85], s[54:55] op_sel_hi:[1,0]
    v_pk_mul_f32 v[198:199], v[86:87], s[54:55] op_sel_hi:[1,0]
    v_exp_f32 v192, v192
    v_exp_f32 v193, v193
    v_exp_f32 v194, v194
    v_exp_f32 v195, v195
    v_exp_f32 v196, v196
    v_exp_f32 v197, v197
    v_exp_f32 v198, v198
    v_exp_f32 v199, v199
    v_mfma_f32_32x32x16_bf16 v[96:111], v[152:155], a[200:203], v[96:111]
    ds_read_b64_tr_b16 v[136:137], v224 offset:53248
    ds_read_b64_tr_b16 v[138:139], v224 offset:53504
    buffer_load_dwordx4 v234, s[16:19], s48 offen offset:1024 lds
    v_pk_add_f32 v[192:193], v[192:193], 1.0 op_sel_hi:[1,0]
    v_pk_add_f32 v[194:195], v[194:195], 1.0 op_sel_hi:[1,0]
    v_pk_add_f32 v[196:197], v[196:197], 1.0 op_sel_hi:[1,0]
    v_pk_add_f32 v[198:199], v[198:199], 1.0 op_sel_hi:[1,0]
    v_rcp_f32 v192, v192
    v_rcp_f32 v193, v193
    v_rcp_f32 v194, v194
    v_rcp_f32 v195, v195
    v_rcp_f32 v196, v196
    v_rcp_f32 v197, v197
    v_rcp_f32 v198, v198
    v_rcp_f32 v199, v199
    v_mfma_f32_32x32x16_bf16 v[96:111], v[156:159], a[204:207], v[96:111]
    ds_read_b64_tr_b16 v[140:141], v224 offset:61440
    ds_read_b64_tr_b16 v[142:143], v224 offset:61696
    s_add_u32 m0, s46, 4096
    s_lshl4_add_u32 s48, s70, 32768
    buffer_load_dwordx4 v233, s[16:19], s48 offen lds
    v_pk_mul_f32 v[80:81], v[80:81], v[192:193]
    v_pk_mul_f32 v[82:83], v[82:83], v[194:195]
    s_waitcnt vmcnt(26)
    ds_read_b64_tr_b16 a[96:97], v239 offset:2048
    ds_read_b64_tr_b16 a[100:101], v240 offset:2048
    ds_read_b64_tr_b16 a[98:99], v239 offset:3072
    ds_read_b64_tr_b16 a[102:103], v240 offset:3072
    v_pk_mul_f32 v[84:85], v[84:85], v[196:197]
    v_pk_mul_f32 v[86:87], v[86:87], v[198:199]
    v_cvt_pk_bf16_f32 v80, v80, v81
    v_cvt_pk_bf16_f32 v81, v82, v83
    v_cvt_pk_bf16_f32 v82, v84, v85
    v_cvt_pk_bf16_f32 v83, v86, v87
    buffer_store_dwordx4 v[80:83], v244, s[24:27], s59 offen offset:2048 sc1
    v_pk_mul_f32 v[200:201], v[88:89], s[54:55] op_sel_hi:[1,0]
    v_pk_mul_f32 v[202:203], v[90:91], s[54:55] op_sel_hi:[1,0]
    v_pk_mul_f32 v[204:205], v[92:93], s[54:55] op_sel_hi:[1,0]
    v_pk_mul_f32 v[206:207], v[94:95], s[54:55] op_sel_hi:[1,0]
    v_exp_f32 v200, v200
    v_exp_f32 v201, v201
    v_exp_f32 v202, v202
    v_exp_f32 v203, v203
    s_waitcnt lgkmcnt(15)
    v_mfma_f32_32x32x16_bf16 v[96:111], v[112:115], a[208:211], v[96:111]
    ds_read_b64_tr_b16 v[144:145], v224 offset:37888
    ds_read_b64_tr_b16 v[146:147], v224 offset:38144
    buffer_load_dword v243, v231, s[24:27], s89 offen sc1
    buffer_load_dwordx4 v234, s[16:19], s48 offen offset:1024 lds
    v_exp_f32 v204, v204
    v_exp_f32 v205, v205
    v_exp_f32 v206, v206
    v_exp_f32 v207, v207
    s_waitcnt vmcnt(27)
    ds_read_b64_tr_b16 a[104:105], v235 offset:32768
    ds_read_b64_tr_b16 a[108:109], v236 offset:32768
    ds_read_b64_tr_b16 a[106:107], v235 offset:33792
    ds_read_b64_tr_b16 a[110:111], v236 offset:33792
    v_pk_add_f32 v[200:201], v[200:201], 1.0 op_sel_hi:[1,0]
    v_pk_add_f32 v[202:203], v[202:203], 1.0 op_sel_hi:[1,0]
    v_pk_add_f32 v[204:205], v[204:205], 1.0 op_sel_hi:[1,0]
    v_pk_add_f32 v[206:207], v[206:207], 1.0 op_sel_hi:[1,0]
    v_rcp_f32 v200, v200
    v_rcp_f32 v201, v201
    v_rcp_f32 v202, v202
    v_rcp_f32 v203, v203
    v_mfma_f32_32x32x16_bf16 v[96:111], v[116:119], a[212:215], v[96:111]
    ds_read_b64_tr_b16 v[148:149], v224 offset:46080
    ds_read_b64_tr_b16 v[150:151], v224 offset:46336
    s_waitcnt lgkmcnt(15)
    s_add_u32 m0, s46, 131072
    s_lshl4_add_u32 s48, s71, 0
    buffer_load_dwordx4 v233, s[16:19], s48 offen lds
    v_rcp_f32 v204, v204
    v_rcp_f32 v205, v205
    v_rcp_f32 v206, v206
    v_rcp_f32 v207, v207
    v_pk_mul_f32 v[88:89], v[88:89], v[200:201]
    v_pk_mul_f32 v[90:91], v[90:91], v[202:203]
    v_pk_mul_f32 v[92:93], v[92:93], v[204:205]
    v_pk_mul_f32 v[94:95], v[94:95], v[206:207]
    v_cvt_pk_bf16_f32 v88, v88, v89
    v_cvt_pk_bf16_f32 v89, v90, v91
    v_cvt_pk_bf16_f32 v90, v92, v93
    v_cvt_pk_bf16_f32 v91, v94, v95
    buffer_store_dwordx4 v[88:91], v244, s[24:27], s59 offen offset:3072 sc1
    v_mfma_f32_32x32x16_bf16 v[96:111], v[120:123], a[216:219], v[96:111]
    ds_read_b64_tr_b16 v[152:153], v224 offset:54272
    ds_read_b64_tr_b16 v[154:155], v224 offset:54528
    v_mfma_f32_32x32x16_bf16 v[96:111], v[124:127], a[220:223], v[96:111]
    ds_read_b64_tr_b16 v[156:157], v224 offset:62464
    ds_read_b64_tr_b16 v[158:159], v224 offset:62720
    buffer_load_dwordx4 v234, s[16:19], s48 offen offset:1024 lds
    s_waitcnt vmcnt(28)
    ds_read_b64_tr_b16 a[112:113], v235 offset:34816
    ds_read_b64_tr_b16 a[116:117], v236 offset:34816
    ds_read_b64_tr_b16 a[114:115], v235 offset:35840
    ds_read_b64_tr_b16 a[118:119], v236 offset:35840
    s_waitcnt lgkmcnt(15)
    v_mfma_f32_32x32x16_bf16 v[96:111], v[128:131], a[224:227], v[96:111]
    s_waitcnt lgkmcnt(4)
    s_barrier
    s_add_u32 m0, s46, 65536
    s_lshl4_add_u32 s48, s71, 16384
    buffer_load_dwordx4 v233, s[16:19], s48 offen lds
    v_mfma_f32_32x32x16_bf16 v[96:111], v[132:135], a[228:231], v[96:111]
    s_waitcnt vmcnt(27)
    ds_read_b64_tr_b16 a[120:121], v235 offset:36864
    ds_read_b64_tr_b16 a[124:125], v236 offset:36864
    ds_read_b64_tr_b16 a[122:123], v235 offset:37888
    ds_read_b64_tr_b16 a[126:127], v236 offset:37888
    buffer_load_dwordx4 v234, s[16:19], s48 offen offset:1024 lds
    v_mfma_f32_32x32x16_bf16 v[96:111], v[136:139], a[232:235], v[96:111]
    v_mfma_f32_32x32x16_bf16 v[96:111], v[140:143], a[236:239], v[96:111]
    v_mfma_f32_32x32x16_bf16 v[96:111], v[144:147], a[240:243], v[96:111]
    v_mfma_f32_32x32x16_bf16 v[96:111], v[148:151], a[244:247], v[96:111]
    v_mfma_f32_32x32x16_bf16 v[96:111], v[152:155], a[248:251], v[96:111]
    s_add_u32 m0, s46, 67584
    s_lshl4_add_u32 s48, s71, 32768
    buffer_load_dwordx4 v233, s[16:19], s48 offen lds
    s_waitcnt vmcnt(27)
    ds_read_b64_tr_b16 a[128:129], v239 offset:4096
    ds_read_b64_tr_b16 a[132:133], v240 offset:4096
    ds_read_b64_tr_b16 a[130:131], v239 offset:5120
    ds_read_b64_tr_b16 a[134:135], v240 offset:5120
    v_mfma_f32_32x32x16_bf16 v[96:111], v[156:159], a[252:255], v[96:111]
    buffer_load_dwordx4 v234, s[16:19], s48 offen offset:1024 lds
    s_waitcnt vmcnt(26)
    ds_read_b64_tr_b16 a[136:137], v239 offset:6144
    ds_read_b64_tr_b16 a[140:141], v240 offset:6144
    ds_read_b64_tr_b16 a[138:139], v239 offset:7168
    ds_read_b64_tr_b16 a[142:143], v240 offset:7168
    s_waitcnt vmcnt(23)
    ds_read_b64_tr_b16 a[144:145], v235 offset:6144
    ds_read_b64_tr_b16 a[148:149], v236 offset:6144
    ds_read_b64_tr_b16 a[146:147], v235 offset:7168
    ds_read_b64_tr_b16 a[150:151], v236 offset:7168
    s_waitcnt vmcnt(20)
    ds_read_b64_tr_b16 a[152:153], v235 offset:38912
    ds_read_b64_tr_b16 a[156:157], v236 offset:38912
    ds_read_b64_tr_b16 a[154:155], v235 offset:39936
    ds_read_b64_tr_b16 a[158:159], v236 offset:39936
    s_waitcnt vmcnt(17)
    ds_read_b64_tr_b16 a[160:161], v237 offset:6144
    ds_read_b64_tr_b16 a[164:165], v238 offset:6144
    ds_read_b64_tr_b16 a[162:163], v237 offset:7168
    ds_read_b64_tr_b16 a[166:167], v238 offset:7168
    s_add_u32 m0, s46, 69632
    s_lshl4_add_u32 s48, s72, 0
    buffer_load_dwordx4 v233, s[20:23], s48 offen lds
    s_waitcnt vmcnt(16)
    ds_read_b64_tr_b16 a[168:169], v237 offset:38912
    ds_read_b64_tr_b16 a[172:173], v238 offset:38912
    ds_read_b64_tr_b16 a[170:171], v237 offset:39936
    ds_read_b64_tr_b16 a[174:175], v238 offset:39936
    v_pk_mul_f32 v[192:193], v[96:97], s[54:55] op_sel_hi:[1,0]
    v_pk_mul_f32 v[194:195], v[98:99], s[54:55] op_sel_hi:[1,0]
    v_pk_mul_f32 v[196:197], v[100:101], s[54:55] op_sel_hi:[1,0]
    s_waitcnt vmcnt(14)
    ds_read_b64_tr_b16 a[176:177], v235 offset:0
    ds_read_b64_tr_b16 a[180:181], v236 offset:0
    ds_read_b64_tr_b16 a[178:179], v235 offset:1024
    ds_read_b64_tr_b16 a[182:183], v236 offset:1024
    v_pk_mul_f32 v[198:199], v[102:103], s[54:55] op_sel_hi:[1,0]
    v_exp_f32 v192, v192
    buffer_load_dwordx4 v234, s[20:23], s48 offen offset:1024 lds
    v_exp_f32 v193, v193
    v_exp_f32 v194, v194
    v_exp_f32 v195, v195
    v_exp_f32 v196, v196
    v_exp_f32 v197, v197
    v_exp_f32 v198, v198
    v_exp_f32 v199, v199
    v_pk_add_f32 v[192:193], v[192:193], 1.0 op_sel_hi:[1,0]
    v_pk_add_f32 v[194:195], v[194:195], 1.0 op_sel_hi:[1,0]
    v_pk_add_f32 v[196:197], v[196:197], 1.0 op_sel_hi:[1,0]
    s_add_u32 m0, s46, 98304
    s_lshl4_add_u32 s48, s72, 16384
    buffer_load_dwordx4 v233, s[20:23], s48 offen lds
    v_pk_add_f32 v[198:199], v[198:199], 1.0 op_sel_hi:[1,0]
    v_rcp_f32 v192, v192
    v_rcp_f32 v193, v193
    v_rcp_f32 v194, v194
    v_rcp_f32 v195, v195
    v_rcp_f32 v196, v196
    v_rcp_f32 v197, v197
    v_rcp_f32 v198, v198
    buffer_load_dwordx4 v234, s[20:23], s48 offen offset:1024 lds
    s_waitcnt vmcnt(15)
    ds_read_b64_tr_b16 a[184:185], v235 offset:2048
    ds_read_b64_tr_b16 a[188:189], v236 offset:2048
    ds_read_b64_tr_b16 a[186:187], v235 offset:3072
    ds_read_b64_tr_b16 a[190:191], v236 offset:3072
    v_rcp_f32 v199, v199
    v_pk_mul_f32 v[96:97], v[96:97], v[192:193]
    v_pk_mul_f32 v[98:99], v[98:99], v[194:195]
    v_pk_mul_f32 v[100:101], v[100:101], v[196:197]
    v_pk_mul_f32 v[102:103], v[102:103], v[198:199]
    v_cvt_pk_bf16_f32 v96, v96, v97
    v_cvt_pk_bf16_f32 v97, v98, v99
    v_cvt_pk_bf16_f32 v98, v100, v101
    v_cvt_pk_bf16_f32 v99, v102, v103
    buffer_store_dwordx4 v[96:99], v244, s[24:27], s62 offen offset:0 sc1
    v_pk_mul_f32 v[200:201], v[104:105], s[54:55] op_sel_hi:[1,0]
    v_pk_mul_f32 v[202:203], v[106:107], s[54:55] op_sel_hi:[1,0]
    v_pk_mul_f32 v[204:205], v[108:109], s[54:55] op_sel_hi:[1,0]
    v_pk_mul_f32 v[206:207], v[110:111], s[54:55] op_sel_hi:[1,0]
    v_exp_f32 v200, v200
    v_exp_f32 v201, v201
    v_exp_f32 v202, v202
    v_exp_f32 v203, v203
    v_exp_f32 v204, v204
    v_exp_f32 v205, v205
    v_exp_f32 v206, v206
    v_exp_f32 v207, v207
    s_add_u32 m0, s46, 100352
    s_lshl4_add_u32 s48, s73, 0
    buffer_load_dwordx4 v233, s[20:23], s48 offen lds
    v_pk_add_f32 v[200:201], v[200:201], 1.0 op_sel_hi:[1,0]
    v_pk_add_f32 v[202:203], v[202:203], 1.0 op_sel_hi:[1,0]
    v_pk_add_f32 v[204:205], v[204:205], 1.0 op_sel_hi:[1,0]
    v_pk_add_f32 v[206:207], v[206:207], 1.0 op_sel_hi:[1,0]
    v_rcp_f32 v200, v200
    v_rcp_f32 v201, v201
    v_rcp_f32 v202, v202
    v_rcp_f32 v203, v203
    v_rcp_f32 v204, v204
    v_rcp_f32 v205, v205
    buffer_load_dwordx4 v234, s[20:23], s48 offen offset:1024 lds
    v_rcp_f32 v206, v206
    v_rcp_f32 v207, v207
    v_pk_mul_f32 v[104:105], v[104:105], v[200:201]
    v_pk_mul_f32 v[106:107], v[106:107], v[202:203]
    v_pk_mul_f32 v[108:109], v[108:109], v[204:205]
    v_pk_mul_f32 v[110:111], v[110:111], v[206:207]
    v_cvt_pk_bf16_f32 v104, v104, v105
    v_cvt_pk_bf16_f32 v105, v106, v107
    v_cvt_pk_bf16_f32 v106, v108, v109
    v_cvt_pk_bf16_f32 v107, v110, v111
    buffer_store_dwordx4 v[104:107], v244, s[24:27], s62 offen offset:1024 sc1
    s_add_u32 m0, s46, 102400
    s_lshl4_add_u32 s48, s73, 16384
    buffer_load_dwordx4 v233, s[20:23], s48 offen lds
    buffer_load_dwordx4 v234, s[20:23], s48 offen offset:1024 lds
    s_waitcnt vmcnt(18)
    v_cmp_ne_u32 vcc, s47, v243
    s_nop 4
    s_and_b64 s[60:61], vcc, s[76:77]
    s_cbranch_scc1 L_spin5
L_ok4:
    s_waitcnt vmcnt(17)
    ds_read_b64_tr_b16 a[192:193], v235 offset:4096
    ds_read_b64_tr_b16 a[196:197], v236 offset:4096
    ds_read_b64_tr_b16 a[194:195], v235 offset:5120
    ds_read_b64_tr_b16 a[198:199], v236 offset:5120
    buffer_load_dwordx4 v[160:163], v225, s[24:27], s64 offen offset:0 sc1
    buffer_load_dwordx4 v[164:167], v226, s[24:27], s64 offen offset:0 sc1
    buffer_load_dwordx4 v[168:171], v225, s[24:27], s64 offen offset:1024 sc1
    s_waitcnt vmcnt(17)
    ds_read_b64_tr_b16 a[200:201], v239 offset:0
    ds_read_b64_tr_b16 a[204:205], v240 offset:0
    ds_read_b64_tr_b16 a[202:203], v239 offset:1024
    ds_read_b64_tr_b16 a[206:207], v240 offset:1024
    buffer_load_dwordx4 v[172:175], v226, s[24:27], s64 offen offset:1024 sc1
    s_waitcnt vmcnt(16)
    ds_read_b64_tr_b16 a[208:209], v237 offset:0
    ds_read_b64_tr_b16 a[212:213], v238 offset:0
    ds_read_b64_tr_b16 a[210:211], v237 offset:1024
    ds_read_b64_tr_b16 a[214:215], v238 offset:1024
    buffer_load_dwordx4 v[176:179], v225, s[24:27], s64 offen offset:2048 sc1
    buffer_load_dwordx4 v[180:183], v226, s[24:27], s64 offen offset:2048 sc1
    s_waitcnt vmcnt(16)
    ds_read_b64_tr_b16 a[216:217], v237 offset:2048
    ds_read_b64_tr_b16 a[220:221], v238 offset:2048
    ds_read_b64_tr_b16 a[218:219], v237 offset:3072
    ds_read_b64_tr_b16 a[222:223], v238 offset:3072
    buffer_load_dwordx4 v[184:187], v225, s[24:27], s64 offen offset:3072 sc1
    buffer_load_dwordx4 v[188:191], v226, s[24:27], s64 offen offset:3072 sc1
    buffer_load_dwordx4 v[112:115], v225, s[24:27], s65 offen offset:0 sc1
    buffer_load_dwordx4 v[116:119], v226, s[24:27], s65 offen offset:0 sc1
    buffer_load_dwordx4 v[120:123], v225, s[24:27], s65 offen offset:1024 sc1
    buffer_load_dwordx4 v[124:127], v226, s[24:27], s65 offen offset:1024 sc1
    buffer_load_dwordx4 v[128:131], v225, s[24:27], s65 offen offset:2048 sc1
    buffer_load_dwordx4 v[132:135], v226, s[24:27], s65 offen offset:2048 sc1
    buffer_load_dwordx4 v[136:139], v225, s[24:27], s65 offen offset:3072 sc1
    buffer_load_dwordx4 v[140:143], v226, s[24:27], s65 offen offset:3072 sc1
    buffer_load_dwordx4 v[144:147], v225, s[24:27], s66 offen offset:0 sc1
    s_waitcnt vmcnt(19)
    buffer_store_dword v230, v245, s[24:27], 0 offen offset:32 sc1
    s_waitcnt vmcnt(16)
    v_mfma_f32_32x32x16_bf16 v[0:15], a[0:3], v[160:163], 0
    v_mfma_f32_32x32x16_bf16 v[16:31], a[4:7], v[160:163], 0
    v_mfma_f32_32x32x16_bf16 v[32:47], a[0:3], v[164:167], 0
    buffer_load_dwordx4 v[148:151], v226, s[24:27], s66 offen offset:0 sc1
    v_mfma_f32_32x32x16_bf16 v[48:63], a[4:7], v[164:167], 0
    buffer_load_dwordx4 v[152:155], v225, s[24:27], s66 offen offset:1024 sc1
    s_waitcnt vmcnt(16)
    v_mfma_f32_32x32x16_bf16 v[0:15], a[8:11], v[168:171], v[0:15]
    v_mfma_f32_32x32x16_bf16 v[16:31], a[12:15], v[168:171], v[16:31]
    v_mfma_f32_32x32x16_bf16 v[32:47], a[8:11], v[172:175], v[32:47]
    buffer_load_dwordx4 v[156:159], v226, s[24:27], s66 offen offset:1024 sc1
    v_mfma_f32_32x32x16_bf16 v[48:63], a[12:15], v[172:175], v[48:63]
    ds_read_b64_tr_b16 a[0:1], v237 offset:4096
    ds_read_b64_tr_b16 a[4:5], v238 offset:4096
    ds_read_b64_tr_b16 a[2:3], v237 offset:5120
    ds_read_b64_tr_b16 a[6:7], v238 offset:5120
    buffer_load_dwordx4 v[64:67], v225, s[24:27], s66 offen offset:2048 sc1
    s_waitcnt vmcnt(16)
    v_mfma_f32_32x32x16_bf16 v[0:15], a[16:19], v[176:179], v[0:15]
    v_mfma_f32_32x32x16_bf16 v[16:31], a[20:23], v[176:179], v[16:31]
    v_mfma_f32_32x32x16_bf16 v[32:47], a[16:19], v[180:183], v[32:47]
    buffer_load_dwordx4 v[68:71], v226, s[24:27], s66 offen offset:2048 sc1
    v_mfma_f32_32x32x16_bf16 v[48:63], a[20:23], v[180:183], v[48:63]
    ds_read_b64_tr_b16 a[8:9], v237 offset:32768
    ds_read_b64_tr_b16 a[12:13], v238 offset:32768
    ds_read_b64_tr_b16 a[10:11], v237 offset:33792
    ds_read_b64_tr_b16 a[14:15], v238 offset:33792
    buffer_load_dwordx4 v[72:75], v225, s[24:27], s66 offen offset:3072 sc1
    s_waitcnt vmcnt(16)
    v_mfma_f32_32x32x16_bf16 v[0:15], a[24:27], v[184:187], v[0:15]
    v_mfma_f32_32x32x16_bf16 v[16:31], a[28:31], v[184:187], v[16:31]
    v_mfma_f32_32x32x16_bf16 v[32:47], a[24:27], v[188:191], v[32:47]
    buffer_load_dwordx4 v[76:79], v226, s[24:27], s66 offen offset:3072 sc1
    v_mfma_f32_32x32x16_bf16 v[48:63], a[28:31], v[188:191], v[48:63]
    ds_read_b64_tr_b16 a[16:17], v237 offset:34816
    ds_read_b64_tr_b16 a[20:21], v238 offset:34816
    ds_read_b64_tr_b16 a[18:19], v237 offset:35840
    ds_read_b64_tr_b16 a[22:23], v238 offset:35840
    buffer_load_dwordx4 v[80:83], v225, s[24:27], s67 offen offset:0 sc1
    s_waitcnt vmcnt(16)
    v_mfma_f32_32x32x16_bf16 v[0:15], a[32:35], v[112:115], v[0:15]
    v_mfma_f32_32x32x16_bf16 v[16:31], a[36:39], v[112:115], v[16:31]
    v_mfma_f32_32x32x16_bf16 v[32:47], a[32:35], v[116:119], v[32:47]
    buffer_load_dwordx4 v[84:87], v226, s[24:27], s67 offen offset:0 sc1
    v_mfma_f32_32x32x16_bf16 v[48:63], a[36:39], v[116:119], v[48:63]
    ds_read_b64_tr_b16 a[24:25], v237 offset:36864
    ds_read_b64_tr_b16 a[28:29], v238 offset:36864
    ds_read_b64_tr_b16 a[26:27], v237 offset:37888
    ds_read_b64_tr_b16 a[30:31], v238 offset:37888
    buffer_load_dwordx4 v[88:91], v225, s[24:27], s67 offen offset:1024 sc1
    s_waitcnt vmcnt(16)
    v_mfma_f32_32x32x16_bf16 v[0:15], a[40:43], v[120:123], v[0:15]
    v_mfma_f32_32x32x16_bf16 v[16:31], a[44:47], v[120:123], v[16:31]
    v_mfma_f32_32x32x16_bf16 v[32:47], a[40:43], v[124:127], v[32:47]
    buffer_load_dwordx4 v[92:95], v226, s[24:27], s67 offen offset:1024 sc1
    v_mfma_f32_32x32x16_bf16 v[48:63], a[44:47], v[124:127], v[48:63]
    buffer_load_dwordx4 v[96:99], v225, s[24:27], s67 offen offset:2048 sc1
    s_waitcnt vmcnt(16)
    v_mfma_f32_32x32x16_bf16 v[0:15], a[48:51], v[128:131], v[0:15]
    v_mfma_f32_32x32x16_bf16 v[16:31], a[52:55], v[128:131], v[16:31]
    v_mfma_f32_32x32x16_bf16 v[32:47], a[48:51], v[132:135], v[32:47]
    buffer_load_dwordx4 v[100:103], v226, s[24:27], s67 offen offset:2048 sc1
    v_mfma_f32_32x32x16_bf16 v[48:63], a[52:55], v[132:135], v[48:63]
    buffer_load_dwordx4 v[104:107], v225, s[24:27], s67 offen offset:3072 sc1
    s_waitcnt vmcnt(16)
    v_mfma_f32_32x32x16_bf16 v[0:15], a[56:59], v[136:139], v[0:15]
    v_mfma_f32_32x32x16_bf16 v[16:31], a[60:63], v[136:139], v[16:31]
    v_mfma_f32_32x32x16_bf16 v[32:47], a[56:59], v[140:143], v[32:47]
    buffer_load_dwordx4 v[108:111], v226, s[24:27], s67 offen offset:3072 sc1
    v_mfma_f32_32x32x16_bf16 v[48:63], a[60:63], v[140:143], v[48:63]
    s_add_u32 m0, s46, 133120
    s_lshl4_add_u32 s48, s74, 0
    buffer_load_dwordx4 v233, s[20:23], s48 offen lds
    buffer_load_dwordx4 v234, s[20:23], s48 offen offset:1024 lds
    s_add_u32 m0, s46, 32768
    s_lshl4_add_u32 s48, s74, 16384
    buffer_load_dwordx4 v233, s[20:23], s48 offen lds
    s_waitcnt vmcnt(17)
    v_mfma_f32_32x32x16_bf16 v[0:15], a[64:67], v[144:147], v[0:15]
    v_mfma_f32_32x32x16_bf16 v[16:31], a[68:71], v[144:147], v[16:31]
    buffer_load_dwordx4 v234, s[20:23], s48 offen offset:1024 lds
    v_mfma_f32_32x32x16_bf16 v[32:47], a[64:67], v[148:151], v[32:47]
    v_mfma_f32_32x32x16_bf16 v[48:63], a[68:71], v[148:151], v[48:63]
    buffer_load_dword v243, v231, s[24:27], s89 offen sc1
    buffer_load_dwordx2 v[252:253], v232, s[24:27], s90 offen sc1
    s_waitcnt vmcnt(18)
    v_mfma_f32_32x32x16_bf16 v[0:15], a[72:75], v[152:155], v[0:15]
    v_mfma_f32_32x32x16_bf16 v[16:31], a[76:79], v[152:155], v[16:31]
    v_mfma_f32_32x32x16_bf16 v[32:47], a[72:75], v[156:159], v[32:47]
    s_waitcnt lgkmcnt(15)
    s_add_u32 m0, s46, 34816
    s_lshl4_add_u32 s48, s75, 0
    buffer_load_dwordx4 v233, s[20:23], s48 offen lds
    v_mfma_f32_32x32x16_bf16 v[48:63], a[76:79], v[156:159], v[48:63]
    s_waitcnt vmcnt(17)
    v_mfma_f32_32x32x16_bf16 v[0:15], a[80:83], v[64:67], v[0:15]
    buffer_load_dwordx4 v234, s[20:23], s48 offen offset:1024 lds
    v_mfma_f32_32x32x16_bf16 v[16:31], a[84:87], v[64:67], v[16:31]
    v_mfma_f32_32x32x16_bf16 v[32:47], a[80:83], v[68:71], v[32:47]
    s_add_u32 m0, s46, 36864
    s_lshl4_add_u32 s48, s75, 16384
    buffer_load_dwordx4 v233, s[20:23], s48 offen lds
    v_mfma_f32_32x32x16_bf16 v[48:63], a[84:87], v[68:71], v[48:63]
    s_waitcnt vmcnt(17)
    v_mfma_f32_32x32x16_bf16 v[0:15], a[88:91], v[72:75], v[0:15]
    v_mfma_f32_32x32x16_bf16 v[16:31], a[92:95], v[72:75], v[16:31]
    buffer_load_dwordx4 v234, s[20:23], s48 offen offset:1024 lds
    v_mfma_f32_32x32x16_bf16 v[32:47], a[88:91], v[76:79], v[32:47]
    v_mfma_f32_32x32x16_bf16 v[48:63], a[92:95], v[76:79], v[48:63]
    s_waitcnt vmcnt(16)
    v_mfma_f32_32x32x16_bf16 v[0:15], a[96:99], v[80:83], v[0:15]
    v_mfma_f32_32x32x16_bf16 v[16:31], a[100:103], v[80:83], v[16:31]
    v_mfma_f32_32x32x16_bf16 v[32:47], a[96:99], v[84:87], v[32:47]
    v_mfma_f32_32x32x16_bf16 v[48:63], a[100:103], v[84:87], v[48:63]
    s_waitcnt vmcnt(14)
    v_mfma_f32_32x32x16_bf16 v[0:15], a[104:107], v[88:91], v[0:15]
    v_mfma_f32_32x32x16_bf16 v[16:31], a[108:111], v[88:91], v[16:31]
    v_mfma_f32_32x32x16_bf16 v[32:47], a[104:107], v[92:95], v[32:47]
    v_mfma_f32_32x32x16_bf16 v[48:63], a[108:111], v[92:95], v[48:63]
    s_waitcnt vmcnt(12)
    v_mfma_f32_32x32x16_bf16 v[0:15], a[112:115], v[96:99], v[0:15]
    v_mfma_f32_32x32x16_bf16 v[16:31], a[116:119], v[96:99], v[16:31]
    v_mfma_f32_32x32x16_bf16 v[32:47], a[112:115], v[100:103], v[32:47]
    v_mfma_f32_32x32x16_bf16 v[48:63], a[116:119], v[100:103], v[48:63]
    s_waitcnt vmcnt(10)
    v_mfma_f32_32x32x16_bf16 v[0:15], a[120:123], v[104:107], v[0:15]
    v_mfma_f32_32x32x16_bf16 v[16:31], a[124:127], v[104:107], v[16:31]
    v_mfma_f32_32x32x16_bf16 v[32:47], a[120:123], v[108:111], v[32:47]
    v_mfma_f32_32x32x16_bf16 v[48:63], a[124:127], v[108:111], v[48:63]
    s_waitcnt vmcnt(5)
    v_cmp_ne_u32 vcc, s47, v243
    s_nop 4
    s_and_b64 s[60:61], vcc, s[82:83]
    s_cbranch_scc1 L_spin8
L_ok7:
    buffer_load_dwordx4 v[160:163], v225, s[24:27], s68 offen offset:0 sc1
    ds_read_b64_tr_b16 a[32:33], v239 offset:2048
    ds_read_b64_tr_b16 a[36:37], v240 offset:2048
    ds_read_b64_tr_b16 a[34:35], v239 offset:3072
    ds_read_b64_tr_b16 a[38:39], v240 offset:3072
    buffer_load_dwordx4 v[164:167], v226, s[24:27], s68 offen offset:0 sc1
    s_waitcnt vmcnt(6)
    v_cmp_ne_u32 vcc, s47, v252
    v_cmp_ne_u32 s[60:61], s47, v253
    s_nop 4
    s_or_b64 s[60:61], vcc, s[60:61]
    s_cbranch_scc1 L_spin11
L_ok10:
    ds_read_b64_tr_b16 a[40:41], v235 offset:32768
    ds_read_b64_tr_b16 a[44:45], v236 offset:32768
    ds_read_b64_tr_b16 a[42:43], v235 offset:33792
    ds_read_b64_tr_b16 a[46:47], v236 offset:33792
    buffer_load_dwordx4 v[168:171], v225, s[24:27], s68 offen offset:1024 sc1
    buffer_load_dwordx4 v[172:175], v226, s[24:27], s68 offen offset:1024 sc1
    buffer_load_dwordx4 v[176:179], v225, s[24:27], s68 offen offset:2048 sc1
    s_waitcnt vmcnt(7)
    ds_read_b64_tr_b16 a[48:49], v235 offset:34816
    ds_read_b64_tr_b16 a[52:53], v236 offset:34816
    ds_read_b64_tr_b16 a[50:51], v235 offset:35840
    ds_read_b64_tr_b16 a[54:55], v236 offset:35840
    buffer_load_dwordx4 v[180:183], v226, s[24:27], s68 offen offset:2048 sc1
    buffer_load_dwordx4 v[184:187], v225, s[24:27], s69 offen offset:0 sc1
    s_waitcnt vmcnt(7)
    ds_read_b64_tr_b16 a[56:57], v235 offset:36864
    ds_read_b64_tr_b16 a[60:61], v236 offset:36864
    ds_read_b64_tr_b16 a[58:59], v235 offset:37888
    ds_read_b64_tr_b16 a[62:63], v236 offset:37888
    buffer_load_dwordx4 v[188:191], v226, s[24:27], s69 offen offset:0 sc1
    buffer_load_dwordx4 v[112:115], v242, s[24:27], s88 offen offset:0 sc1
    buffer_load_dwordx4 v[116:119], v242, s[24:27], s88 offen offset:1024 sc1
    buffer_load_dwordx4 v[120:123], v227, s[24:27], s72 offen offset:0 sc1
    buffer_load_dwordx4 v[124:127], v228, s[24:27], s72 offen offset:0 sc1
    buffer_load_dwordx4 a[224:227], v229, s[24:27], s72 offen offset:0 sc1
    buffer_load_dwordx4 v[128:131], v225, s[24:27], s69 offen offset:1024 sc1
    buffer_load_dwordx4 v[132:135], v226, s[24:27], s69 offen offset:1024 sc1
    buffer_load_dwordx4 v[136:139], v227, s[24:27], s72 offen offset:1024 sc1
    buffer_load_dwordx4 v[140:143], v228, s[24:27], s72 offen offset:1024 sc1
    s_waitcnt vmcnt(15)
    v_mfma_f32_32x32x16_bf16 v[0:15], a[128:131], v[160:163], v[0:15]
    v_mfma_f32_32x32x16_bf16 v[16:31], a[132:135], v[160:163], v[16:31]
    buffer_load_dwordx4 a[228:231], v229, s[24:27], s72 offen offset:1024 sc1
    v_mfma_f32_32x32x16_bf16 v[32:47], a[128:131], v[164:167], v[32:47]
    v_mfma_f32_32x32x16_bf16 v[48:63], a[132:135], v[164:167], v[48:63]
    buffer_load_dwordx4 v[144:147], v225, s[24:27], s69 offen offset:2048 sc1
    s_waitcnt vmcnt(15)
    v_mfma_f32_32x32x16_bf16 v[0:15], a[136:139], v[168:171], v[0:15]
    v_mfma_f32_32x32x16_bf16 v[16:31], a[140:143], v[168:171], v[16:31]
    buffer_load_dwordx4 v[148:151], v226, s[24:27], s69 offen offset:2048 sc1
    v_mfma_f32_32x32x16_bf16 v[32:47], a[136:139], v[172:175], v[32:47]
    v_mfma_f32_32x32x16_bf16 v[48:63], a[140:143], v[172:175], v[48:63]
    buffer_load_dwordx4 v[152:155], v227, s[24:27], s73 offen offset:0 sc1
    s_waitcnt vmcnt(15)
    v_mfma_f32_32x32x16_bf16 v[0:15], a[144:147], v[176:179], v[0:15]
    v_mfma_f32_32x32x16_bf16 v[16:31], a[148:151], v[176:179], v[16:31]
    buffer_load_dwordx4 v[156:159], v228, s[24:27], s73 offen offset:0 sc1
    v_mfma_f32_32x32x16_bf16 v[32:47], a[144:147], v[180:183], v[32:47]
    v_mfma_f32_32x32x16_bf16 v[48:63], a[148:151], v[180:183], v[48:63]
    buffer_load_dwordx4 a[232:235], v229, s[24:27], s73 offen offset:0 sc1
    s_waitcnt vmcnt(15)
    v_mfma_f32_32x32x16_bf16 v[0:15], a[152:155], v[184:187], v[0:15]
    v_mfma_f32_32x32x16_bf16 v[16:31], a[156:159], v[184:187], v[16:31]
    buffer_load_dwordx4 v[64:67], v225, s[24:27], s70 offen offset:0 sc1
    v_mfma_f32_32x32x16_bf16 v[32:47], a[152:155], v[188:191], v[32:47]
    v_mfma_f32_32x32x16_bf16 v[48:63], a[156:159], v[188:191], v[48:63]
    buffer_load_dwordx4 v[68:71], v226, s[24:27], s70 offen offset:0 sc1
    buffer_load_dwordx4 v[72:75], v227, s[24:27], s73 offen offset:1024 sc1
    s_waitcnt vmcnt(16)
    v_add_f32 v112, v112, v113
    v_add_f32 v114, v114, v115
    v_add_f32 v112, v112, v114
    v_mov_b32 v113, v112
    s_nop 1
    v_permlane32_swap_b32 v112, v113
    v_add_f32 v112, v112, v113
    v_min_f32 v112, 0x41f00000, v112
    v_mul_f32 v112, 0x3fb8aa3b, v112
    v_exp_f32 v248, v112
    s_nop 0
    v_add_f32 v112, 1.0, v248
    v_rcp_f32 v250, v112
    v_add_f32 v116, v116, v117
    v_add_f32 v118, v118, v119
    v_add_f32 v116, v116, v118
    v_mov_b32 v117, v116
    s_nop 1
    v_permlane32_swap_b32 v116, v117
    v_add_f32 v116, v116, v117
    v_min_f32 v116, 0x41f00000, v116
    v_mul_f32 v116, 0x3fb8aa3b, v116
    v_exp_f32 v249, v116
    buffer_load_dwordx4 v[76:79], v228, s[24:27], s73 offen offset:1024 sc1
    v_add_f32 v116, 1.0, v249
    v_rcp_f32 v251, v116
    s_waitcnt lgkmcnt(0)
    v_lshrrev_b32 v224, 5, v241
    v_and_b32 v254, 7, v241
    v_xor_b32 v224, v224, v254
    v_lshlrev_b32 v224, 4, v224
    v_and_b32 v255, 31, v241
    v_lshl_add_u32 v224, v255, 8, v224
    v_add_u32 v233, s46, v224
    v_xor_b32 v234, 32, v233
    v_xor_b32 v235, 64, v233
    v_xor_b32 v236, 96, v233
    v_lshrrev_b32 v255, 3, v241
    v_lshlrev_b32 v224, 1, v254
    v_xor_b32 v224, v224, v255
    buffer_load_dwordx4 a[236:239], v229, s[24:27], s73 offen offset:1024 sc1
    v_lshlrev_b32 v224, 4, v224
    v_lshl_add_u32 v224, v255, 8, v224
    s_lshl_b32 s51, s40, 11
    v_add_u32 v237, s51, v224
    v_xor_b32 v238, 16, v237
    v_lshlrev_b32 v224, 10, v255
    v_lshl_add_u32 v239, v254, 4, v224
    s_lshl_b32 s51, s40, 5
    v_lshl_add_u32 v240, v255, 2, s51
    s_waitcnt vmcnt(15)
    v_mfma_f32_32x32x16_bf16 v[192:207], a[224:227], v[120:123], 0
    v_mfma_f32_32x32x16_bf16 v[208:223], a[224:227], v[124:127], 0
    buffer_load_dwordx4 v[80:83], v225, s[24:27], s70 offen offset:1024 sc1
    buffer_load_dwordx4 v[84:87], v226, s[24:27], s70 offen offset:1024 sc1
    s_nop 8
    v_add_f32 v252, 0x358637bd, v200
    v_rcp_f32 v252, v252
    s_nop 0
    v_mul_f32 v252, v252, v248
    v_mul_f32 v192, v192, v252
    v_mul_f32 v193, v193, v252
    v_mul_f32 v194, v194, v252
    v_mul_f32 v195, v195, v252
    v_mul_f32 v196, v196, v252
    v_mul_f32 v197, v197, v252
    v_mul_f32 v198, v198, v252
    v_mul_f32 v199, v199, v252
    v_cvt_pk_bf16_f32 v192, v192, v193
    v_cvt_pk_bf16_f32 v193, v194, v195
    v_cvt_pk_bf16_f32 v194, v196, v197
    v_cvt_pk_bf16_f32 v195, v198, v199
    s_waitcnt vmcnt(15)
    v_mfma_f32_32x32x16_bf16 v[0:15], a[160:163], v[128:131], v[0:15]
    v_add_f32 v253, 0x358637bd, v216
    v_rcp_f32 v253, v253
    s_nop 0
    v_mul_f32 v253, v253, v249
    buffer_load_dwordx4 v[88:91], v227, s[24:27], s74 offen offset:0 sc1
    v_mul_f32 v208, v208, v253
    v_mul_f32 v209, v209, v253
    v_mfma_f32_32x32x16_bf16 v[16:31], a[164:167], v[128:131], v[16:31]
    v_mul_f32 v210, v210, v253
    v_mul_f32 v211, v211, v253
    v_mul_f32 v212, v212, v253
    v_mul_f32 v213, v213, v253
    v_mul_f32 v214, v214, v253
    v_mul_f32 v215, v215, v253
    v_mfma_f32_32x32x16_bf16 v[32:47], a[160:163], v[132:135], v[32:47]
    v_cvt_pk_bf16_f32 v208, v208, v209
    v_cvt_pk_bf16_f32 v209, v210, v211
    v_cvt_pk_bf16_f32 v210, v212, v213
    v_cvt_pk_bf16_f32 v211, v214, v215
    v_mfma_f32_32x32x16_bf16 v[48:63], a[164:167], v[132:135], v[48:63]
    buffer_load_dwordx4 v[92:95], v228, s[24:27], s74 offen offset:0 sc1
    v_mfma_f32_32x32x16_bf16 v[0:15], a[0:3], v[192:195], v[0:15]
    v_mfma_f32_32x32x16_bf16 v[16:31], a[4:7], v[192:195], v[16:31]
    buffer_load_dwordx4 a[240:243], v229, s[24:27], s74 offen offset:0 sc1
    v_mfma_f32_32x32x16_bf16 v[32:47], a[0:3], v[208:211], v[32:47]
    v_mfma_f32_32x32x16_bf16 v[48:63], a[4:7], v[208:211], v[48:63]
    s_waitcnt vmcnt(15)
    v_mfma_f32_32x32x16_bf16 v[192:207], a[228:231], v[136:139], 0
    buffer_load_dwordx4 v[96:99], v225, s[24:27], s70 offen offset:2048 sc1
    v_mfma_f32_32x32x16_bf16 v[208:223], a[228:231], v[140:143], 0
    buffer_load_dwordx4 v[100:103], v226, s[24:27], s70 offen offset:2048 sc1
    s_waitcnt vmcnt(15)
    v_mfma_f32_32x32x16_bf16 v[0:15], a[168:171], v[144:147], v[0:15]
    s_nop 6
    v_add_f32 v252, 0x358637bd, v192
    v_rcp_f32 v252, v252
    s_nop 0
    v_mul_f32 v252, v252, v248
    buffer_load_dwordx4 v[104:107], v227, s[24:27], s74 offen offset:1024 sc1
    v_mul_f32 v200, v200, v252
    v_mul_f32 v201, v201, v252
    v_mfma_f32_32x32x16_bf16 v[16:31], a[172:175], v[144:147], v[16:31]
    v_mul_f32 v202, v202, v252
    v_mul_f32 v203, v203, v252
    v_mul_f32 v204, v204, v252
    v_mul_f32 v205, v205, v252
    v_mul_f32 v206, v206, v252
    v_mul_f32 v207, v207, v252
    v_mfma_f32_32x32x16_bf16 v[32:47], a[168:171], v[148:151], v[32:47]
    v_cvt_pk_bf16_f32 v200, v200, v201
    v_cvt_pk_bf16_f32 v201, v202, v203
    v_cvt_pk_bf16_f32 v202, v204, v205
    v_cvt_pk_bf16_f32 v203, v206, v207
    v_add_f32 v253, 0x358637bd, v208
    buffer_load_dwordx4 v[108:111], v228, s[24:27], s74 offen offset:1024 sc1
    v_rcp_f32 v253, v253
    v_mfma_f32_32x32x16_bf16 v[48:63], a[172:175], v[148:151], v[48:63]
    v_mul_f32 v253, v253, v249
    v_mul_f32 v216, v216, v253
    v_mul_f32 v217, v217, v253
    v_mul_f32 v218, v218, v253
    v_mul_f32 v219, v219, v253
    v_mul_f32 v220, v220, v253
    v_mfma_f32_32x32x16_bf16 v[0:15], a[8:11], v[200:203], v[0:15]
    v_mul_f32 v221, v221, v253
    v_mul_f32 v222, v222, v253
    v_mul_f32 v223, v223, v253
    v_cvt_pk_bf16_f32 v216, v216, v217
    v_cvt_pk_bf16_f32 v217, v218, v219
    buffer_load_dwordx4 a[244:247], v229, s[24:27], s74 offen offset:1024 sc1
    v_cvt_pk_bf16_f32 v218, v220, v221
    v_mfma_f32_32x32x16_bf16 v[16:31], a[12:15], v[200:203], v[16:31]
    v_cvt_pk_bf16_f32 v219, v222, v223
    s_nop 1
    v_mfma_f32_32x32x16_bf16 v[32:47], a[8:11], v[216:219], v[32:47]
    v_mfma_f32_32x32x16_bf16 v[48:63], a[12:15], v[216:219], v[48:63]
    buffer_load_dwordx4 v[112:115], v225, s[24:27], s71 offen offset:0 sc1
    s_waitcnt vmcnt(16)
    v_mfma_f32_32x32x16_bf16 v[192:207], a[232:235], v[152:155], 0
    v_mfma_f32_32x32x16_bf16 v[208:223], a[232:235], v[156:159], 0
    buffer_load_dwordx4 v[116:119], v226, s[24:27], s71 offen offset:0 sc1
    s_waitcnt vmcnt(15)
    v_mfma_f32_32x32x16_bf16 v[0:15], a[176:179], v[64:67], v[0:15]
    s_nop 7
    v_add_f32 v252, 0x358637bd, v200
    v_rcp_f32 v252, v252
    s_nop 0
    v_mul_f32 v252, v252, v248
    buffer_load_dwordx4 v[160:163], v227, s[24:27], s75 offen offset:0 sc1
    v_mul_f32 v192, v192, v252
    v_mul_f32 v193, v193, v252
    v_mfma_f32_32x32x16_bf16 v[16:31], a[180:183], v[64:67], v[16:31]
    v_mul_f32 v194, v194, v252
    v_mul_f32 v195, v195, v252
    v_mul_f32 v196, v196, v252
    v_mul_f32 v197, v197, v252
    v_mul_f32 v198, v198, v252
    v_mul_f32 v199, v199, v252
    v_mfma_f32_32x32x16_bf16 v[32:47], a[176:179], v[68:71], v[32:47]
    v_cvt_pk_bf16_f32 v192, v192, v193
    v_cvt_pk_bf16_f32 v193, v194, v195
    v_cvt_pk_bf16_f32 v194, v196, v197
    v_cvt_pk_bf16_f32 v195, v198, v199
    v_add_f32 v253, 0x358637bd, v216
    buffer_load_dwordx4 v[164:167], v228, s[24:27], s75 offen offset:0 sc1
    v_rcp_f32 v253, v253
    v_mfma_f32_32x32x16_bf16 v[48:63], a[180:183], v[68:71], v[48:63]
    v_mul_f32 v253, v253, v249
    v_mul_f32 v208, v208, v253
    v_mul_f32 v209, v209, v253
    v_mul_f32 v210, v210, v253
    v_mul_f32 v211, v211, v253
    v_mul_f32 v212, v212, v253
    v_mfma_f32_32x32x16_bf16 v[0:15], a[16:19], v[192:195], v[0:15]
    v_mul_f32 v213, v213, v253
    v_mul_f32 v214, v214, v253
    v_mul_f32 v215, v215, v253
    v_cvt_pk_bf16_f32 v208, v208, v209
    v_cvt_pk_bf16_f32 v209, v210, v211
    buffer_load_dwordx4 a[248:251], v229, s[24:27], s75 offen offset:0 sc1
    v_cvt_pk_bf16_f32 v210, v212, v213
    v_mfma_f32_32x32x16_bf16 v[16:31], a[20:23], v[192:195], v[16:31]
    v_cvt_pk_bf16_f32 v211, v214, v215
    s_nop 1
    v_mfma_f32_32x32x16_bf16 v[32:47], a[16:19], v[208:211], v[32:47]
    v_mfma_f32_32x32x16_bf16 v[48:63], a[20:23], v[208:211], v[48:63]
    buffer_load_dwordx4 v[168:171], v225, s[24:27], s71 offen offset:1024 sc1
    s_waitcnt vmcnt(16)
    v_mfma_f32_32x32x16_bf16 v[192:207], a[236:239], v[72:75], 0
    v_mfma_f32_32x32x16_bf16 v[208:223], a[236:239], v[76:79], 0
    buffer_load_dwordx4 v[172:175], v226, s[24:27], s71 offen offset:1024 sc1
    s_waitcnt vmcnt(15)
    v_mfma_f32_32x32x16_bf16 v[0:15], a[184:187], v[80:83], v[0:15]
    s_nop 7
    v_add_f32 v252, 0x358637bd, v192
    v_rcp_f32 v252, v252
    s_nop 0
    v_mul_f32 v252, v252, v248
    buffer_load_dwordx4 v[176:179], v227, s[24:27], s75 offen offset:1024 sc1
    v_mul_f32 v200, v200, v252
    v_mul_f32 v201, v201, v252
    v_mfma_f32_32x32x16_bf16 v[16:31], a[188:191], v[80:83], v[16:31]
    v_mul_f32 v202, v202, v252
    v_mul_f32 v203, v203, v252
    v_mul_f32 v204, v204, v252
    v_mul_f32 v205, v205, v252
    v_mul_f32 v206, v206, v252
    v_mul_f32 v207, v207, v252
    v_mfma_f32_32x32x16_bf16 v[32:47], a[184:187], v[84:87], v[32:47]
    v_cvt_pk_bf16_f32 v200, v200, v201
    v_cvt_pk_bf16_f32 v201, v202, v203
    v_cvt_pk_bf16_f32 v202, v204, v205
    v_cvt_pk_bf16_f32 v203, v206, v207
    v_add_f32 v253, 0x358637bd, v208
    buffer_load_dwordx4 v[180:183], v228, s[24:27], s75 offen offset:1024 sc1
    v_rcp_f32 v253, v253
    v_mfma_f32_32x32x16_bf16 v[48:63], a[188:191], v[84:87], v[48:63]
    v_mul_f32 v253, v253, v249
    v_mul_f32 v216, v216, v253
    v_mul_f32 v217, v217, v253
    v_mul_f32 v218, v218, v253
    v_mul_f32 v219, v219, v253
    v_mul_f32 v220, v220, v253
    v_mfma_f32_32x32x16_bf16 v[0:15], a[24:27], v[200:203], v[0:15]
    v_mul_f32 v221, v221, v253
    v_mul_f32 v222, v222, v253
    v_mul_f32 v223, v223, v253
    v_cvt_pk_bf16_f32 v216, v216, v217
    v_cvt_pk_bf16_f32 v217, v218, v219
    buffer_load_dwordx4 a[252:255], v229, s[24:27], s75 offen offset:1024 sc1
    v_cvt_pk_bf16_f32 v218, v220, v221
    v_mfma_f32_32x32x16_bf16 v[16:31], a[28:31], v[200:203], v[16:31]
    v_cvt_pk_bf16_f32 v219, v222, v223
    s_nop 1
    v_mfma_f32_32x32x16_bf16 v[32:47], a[24:27], v[216:219], v[32:47]
    v_mfma_f32_32x32x16_bf16 v[48:63], a[28:31], v[216:219], v[48:63]
    buffer_load_dwordx4 v[184:187], v225, s[24:27], s71 offen offset:2048 sc1
    s_waitcnt vmcnt(16)
    v_mfma_f32_32x32x16_bf16 v[192:207], a[240:243], v[88:91], 0
    v_mfma_f32_32x32x16_bf16 v[208:223], a[240:243], v[92:95], 0
    buffer_load_dwordx4 v[188:191], v226, s[24:27], s71 offen offset:2048 sc1
    s_waitcnt vmcnt(15)
    v_mfma_f32_32x32x16_bf16 v[0:15], a[192:195], v[96:99], v[0:15]
    s_nop 7
    v_add_f32 v252, 0x358637bd, v200
    v_rcp_f32 v252, v252
    s_nop 0
    v_mul_f32 v252, v252, v248
    v_mul_f32 v192, v192, v252
    v_mul_f32 v193, v193, v252
    v_mfma_f32_32x32x16_bf16 v[16:31], a[196:199], v[96:99], v[16:31]
    v_mul_f32 v194, v194, v252
    v_mul_f32 v195, v195, v252
    v_mul_f32 v196, v196, v252
    v_mul_f32 v197, v197, v252
    v_mul_f32 v198, v198, v252
    v_mul_f32 v199, v199, v252
    v_mfma_f32_32x32x16_bf16 v[32:47], a[192:195], v[100:103], v[32:47]
    v_cvt_pk_bf16_f32 v192, v192, v193
    v_cvt_pk_bf16_f32 v193, v194, v195
    v_cvt_pk_bf16_f32 v194, v196, v197
    v_cvt_pk_bf16_f32 v195, v198, v199
    v_add_f32 v253, 0x358637bd, v216
    v_rcp_f32 v253, v253
    v_mfma_f32_32x32x16_bf16 v[48:63], a[196:199], v[100:103], v[48:63]
    v_mul_f32 v253, v253, v249
    v_mul_f32 v208, v208, v253
    v_mul_f32 v209, v209, v253
    v_mul_f32 v210, v210, v253
    v_mul_f32 v211, v211, v253
    v_mul_f32 v212, v212, v253
    v_mfma_f32_32x32x16_bf16 v[0:15], a[32:35], v[192:195], v[0:15]
    v_mul_f32 v213, v213, v253
    v_mul_f32 v214, v214, v253
    v_mul_f32 v215, v215, v253
    v_cvt_pk_bf16_f32 v208, v208, v209
    v_cvt_pk_bf16_f32 v209, v210, v211
    v_cvt_pk_bf16_f32 v210, v212, v213
    v_mfma_f32_32x32x16_bf16 v[16:31], a[36:39], v[192:195], v[16:31]
    v_cvt_pk_bf16_f32 v211, v214, v215
    s_nop 1
    v_mfma_f32_32x32x16_bf16 v[32:47], a[32:35], v[208:211], v[32:47]
    v_mfma_f32_32x32x16_bf16 v[48:63], a[36:39], v[208:211], v[48:63]
    s_waitcnt vmcnt(12)
    v_mfma_f32_32x32x16_bf16 v[192:207], a[244:247], v[104:107], 0
    v_mfma_f32_32x32x16_bf16 v[208:223], a[244:247], v[108:111], 0
    s_waitcnt vmcnt(10)
    v_mfma_f32_32x32x16_bf16 v[0:15], a[200:203], v[112:115], v[0:15]
    s_nop 8
    v_add_f32 v252, 0x358637bd, v192
    v_rcp_f32 v252, v252
    s_nop 0
    v_mul_f32 v252, v252, v248
    v_mul_f32 v200, v200, v252
    v_mul_f32 v201, v201, v252
    v_mfma_f32_32x32x16_bf16 v[16:31], a[204:207], v[112:115], v[16:31]
    v_mul_f32 v202, v202, v252
    v_mul_f32 v203, v203, v252
    v_mul_f32 v204, v204, v252
    v_mul_f32 v205, v205, v252
    v_mul_f32 v206, v206, v252
    v_mul_f32 v207, v207, v252
    v_mfma_f32_32x32x16_bf16 v[32:47], a[200:203], v[116:119], v[32:47]
    v_cvt_pk_bf16_f32 v200, v200, v201
    v_cvt_pk_bf16_f32 v201, v202, v203
    v_cvt_pk_bf16_f32 v202, v204, v205
    v_cvt_pk_bf16_f32 v203, v206, v207
    v_add_f32 v253, 0x358637bd, v208
    v_rcp_f32 v253, v253
    v_mfma_f32_32x32x16_bf16 v[48:63], a[204:207], v[116:119], v[48:63]
    v_mul_f32 v253, v253, v249
    v_mul_f32 v216, v216, v253
    v_mul_f32 v217, v217, v253
    v_mul_f32 v218, v218, v253
    v_mul_f32 v219, v219, v253
    v_mul_f32 v220, v220, v253
    v_mfma_f32_32x32x16_bf16 v[0:15], a[40:43], v[200:203], v[0:15]
    v_mul_f32 v221, v221, v253
    v_mul_f32 v222, v222, v253
    v_mul_f32 v223, v223, v253
    v_cvt_pk_bf16_f32 v216, v216, v217
    v_cvt_pk_bf16_f32 v217, v218, v219
    v_cvt_pk_bf16_f32 v218, v220, v221
    v_mfma_f32_32x32x16_bf16 v[16:31], a[44:47], v[200:203], v[16:31]
    v_cvt_pk_bf16_f32 v219, v222, v223
    s_nop 1
    v_mfma_f32_32x32x16_bf16 v[32:47], a[40:43], v[216:219], v[32:47]
    v_mfma_f32_32x32x16_bf16 v[48:63], a[44:47], v[216:219], v[48:63]
    s_waitcnt vmcnt(7)
    v_mfma_f32_32x32x16_bf16 v[192:207], a[248:251], v[160:163], 0
    v_mfma_f32_32x32x16_bf16 v[208:223], a[248:251], v[164:167], 0
    s_waitcnt vmcnt(5)
    v_mfma_f32_32x32x16_bf16 v[0:15], a[208:211], v[168:171], v[0:15]
    s_nop 8
    v_add_f32 v252, 0x358637bd, v200
    v_rcp_f32 v252, v252
    s_nop 0
    v_mul_f32 v252, v252, v248
    v_mul_f32 v192, v192, v252
    v_mul_f32 v193, v193, v252
    v_mfma_f32_32x32x16_bf16 v[16:31], a[212:215], v[168:171], v[16:31]
    v_mul_f32 v194, v194, v252
    v_mul_f32 v195, v195, v252
    v_mul_f32 v196, v196, v252
    v_mul_f32 v197, v197, v252
    v_mul_f32 v198, v198, v252
    v_mul_f32 v199, v199, v252
    v_mfma_f32_32x32x16_bf16 v[32:47], a[208:211], v[172:175], v[32:47]
    v_cvt_pk_bf16_f32 v192, v192, v193
    v_cvt_pk_bf16_f32 v193, v194, v195
    v_cvt_pk_bf16_f32 v194, v196, v197
    v_cvt_pk_bf16_f32 v195, v198, v199
    v_add_f32 v253, 0x358637bd, v216
    v_rcp_f32 v253, v253
    v_mfma_f32_32x32x16_bf16 v[48:63], a[212:215], v[172:175], v[48:63]
    v_mul_f32 v253, v253, v249
    v_mul_f32 v208, v208, v253
    v_mul_f32 v209, v209, v253
    v_mul_f32 v210, v210, v253
    v_mul_f32 v211, v211, v253
    v_mul_f32 v212, v212, v253
    v_mfma_f32_32x32x16_bf16 v[0:15], a[48:51], v[192:195], v[0:15]
    v_mul_f32 v213, v213, v253
    v_mul_f32 v214, v214, v253
    v_mul_f32 v215, v215, v253
    v_cvt_pk_bf16_f32 v208, v208, v209
    v_cvt_pk_bf16_f32 v209, v210, v211
    v_cvt_pk_bf16_f32 v210, v212, v213
    v_mfma_f32_32x32x16_bf16 v[16:31], a[52:55], v[192:195], v[16:31]
    v_cvt_pk_bf16_f32 v211, v214, v215
    s_nop 1
    v_mfma_f32_32x32x16_bf16 v[32:47], a[48:51], v[208:211], v[32:47]
    v_mfma_f32_32x32x16_bf16 v[48:63], a[52:55], v[208:211], v[48:63]
    s_waitcnt vmcnt(2)
    v_mfma_f32_32x32x16_bf16 v[192:207], a[252:255], v[176:179], 0
    v_mfma_f32_32x32x16_bf16 v[208:223], a[252:255], v[180:183], 0
    s_waitcnt vmcnt(0)
    v_mfma_f32_32x32x16_bf16 v[0:15], a[216:219], v[184:187], v[0:15]
    s_nop 8
    v_add_f32 v252, 0x358637bd, v192
    v_rcp_f32 v252, v252
    s_nop 0
    v_mul_f32 v252, v252, v248
    v_mul_f32 v200, v200, v252
    v_mul_f32 v201, v201, v252
    v_mfma_f32_32x32x16_bf16 v[16:31], a[220:223], v[184:187], v[16:31]
    v_mul_f32 v202, v202, v252
    v_mul_f32 v203, v203, v252
    v_mul_f32 v204, v204, v252
    v_mul_f32 v205, v205, v252
    v_mul_f32 v206, v206, v252
    v_mul_f32 v207, v207, v252
    v_mfma_f32_32x32x16_bf16 v[32:47], a[216:219], v[188:191], v[32:47]
    v_cvt_pk_bf16_f32 v200, v200, v201
    v_cvt_pk_bf16_f32 v201, v202, v203
    v_cvt_pk_bf16_f32 v202, v204, v205
    v_cvt_pk_bf16_f32 v203, v206, v207
    v_add_f32 v253, 0x358637bd, v208
    v_rcp_f32 v253, v253
    v_mfma_f32_32x32x16_bf16 v[48:63], a[220:223], v[188:191], v[48:63]
    v_mul_f32 v253, v253, v249
    v_mul_f32 v216, v216, v253
    v_mul_f32 v217, v217, v253
    v_mul_f32 v218, v218, v253
    v_mul_f32 v219, v219, v253
    v_mul_f32 v220, v220, v253
    v_mfma_f32_32x32x16_bf16 v[0:15], a[56:59], v[200:203], v[0:15]
    v_mul_f32 v221, v221, v253
    v_mul_f32 v222, v222, v253
    v_mul_f32 v223, v223, v253
    v_cvt_pk_bf16_f32 v216, v216, v217
    v_cvt_pk_bf16_f32 v217, v218, v219
    v_cvt_pk_bf16_f32 v218, v220, v221
    v_mfma_f32_32x32x16_bf16 v[16:31], a[60:63], v[200:203], v[16:31]
    v_cvt_pk_bf16_f32 v219, v222, v223
    s_nop 1
    v_mfma_f32_32x32x16_bf16 v[32:47], a[56:59], v[216:219], v[32:47]
    v_mfma_f32_32x32x16_bf16 v[48:63], a[60:63], v[216:219], v[48:63]
    ds_bpermute_b32 v248, v240, v250
    ds_bpermute_b32 v249, v240, v251
    ds_write_b128 v233, v[0:3] offset:0
    ds_write_b128 v234, v[4:7] offset:0
    ds_write_b128 v235, v[8:11] offset:0
    ds_write_b128 v236, v[12:15] offset:0
    s_nop 0
    ds_write_b128 v233, v[16:19] offset:128
    ds_write_b128 v234, v[20:23] offset:128
    ds_write_b128 v235, v[24:27] offset:128
    ds_write_b128 v236, v[28:31] offset:128
    ds_write_b128 v233, v[32:35] offset:32768
    ds_write_b128 v234, v[36:39] offset:32768
    ds_write_b128 v235, v[40:43] offset:32768
    ds_write_b128 v236, v[44:47] offset:32768
    ds_write_b128 v233, v[48:51] offset:32896
    ds_write_b128 v234, v[52:55] offset:32896
    ds_write_b128 v235, v[56:59] offset:32896
    ds_write_b128 v236, v[60:63] offset:32896
    s_waitcnt lgkmcnt(0)
    s_barrier
    ds_read_b128 v[0:3], v237 offset:0
    ds_read_b128 v[4:7], v238 offset:0
    ds_read_b128 v[8:11], v237 offset:8192
    ds_read_b128 v[12:15], v238 offset:8192
    ds_read_b128 v[16:19], v237 offset:16384
    ds_read_b128 v[20:23], v238 offset:16384
    ds_read_b128 v[24:27], v237 offset:24576
    ds_read_b128 v[28:31], v238 offset:24576
    ds_read_b128 v[32:35], v237 offset:32768
    ds_read_b128 v[36:39], v238 offset:32768
    ds_read_b128 v[40:43], v237 offset:40960
    ds_read_b128 v[44:47], v238 offset:40960
    ds_read_b128 v[48:51], v237 offset:49152
    ds_read_b128 v[52:55], v238 offset:49152
    ds_read_b128 v[56:59], v237 offset:57344
    ds_read_b128 v[60:63], v238 offset:57344
    s_waitcnt lgkmcnt(12)
    v_pk_add_f32 v[0:1], v[0:1], v[8:9]
    v_pk_add_f32 v[2:3], v[2:3], v[10:11]
    v_pk_add_f32 v[4:5], v[4:5], v[12:13]
    v_pk_add_f32 v[6:7], v[6:7], v[14:15]
    s_waitcnt lgkmcnt(8)
    v_pk_add_f32 v[16:17], v[16:17], v[24:25]
    v_pk_add_f32 v[18:19], v[18:19], v[26:27]
    v_pk_add_f32 v[20:21], v[20:21], v[28:29]
    v_pk_add_f32 v[22:23], v[22:23], v[30:31]
    v_pk_add_f32 v[0:1], v[0:1], v[16:17]
    v_pk_add_f32 v[2:3], v[2:3], v[18:19]
    v_pk_add_f32 v[4:5], v[4:5], v[20:21]
    v_pk_add_f32 v[6:7], v[6:7], v[22:23]
    v_mul_f32 v0, v0, v248
    v_mul_f32 v1, v1, v248
    v_mul_f32 v2, v2, v248
    v_mul_f32 v3, v3, v248
    v_mul_f32 v4, v4, v248
    v_mul_f32 v5, v5, v248
    v_mul_f32 v6, v6, v248
    v_mul_f32 v7, v7, v248
    v_cvt_pk_bf16_f32 v0, v0, v1
    v_cvt_pk_bf16_f32 v1, v2, v3
    v_cvt_pk_bf16_f32 v2, v4, v5
    v_cvt_pk_bf16_f32 v3, v6, v7
    buffer_store_dwordx4 v[0:3], v239, s[28:31], s96 offen
    s_waitcnt lgkmcnt(4)
    v_pk_add_f32 v[32:33], v[32:33], v[40:41]
    v_pk_add_f32 v[34:35], v[34:35], v[42:43]
    v_pk_add_f32 v[36:37], v[36:37], v[44:45]
    v_pk_add_f32 v[38:39], v[38:39], v[46:47]
    s_waitcnt lgkmcnt(0)
    v_pk_add_f32 v[48:49], v[48:49], v[56:57]
    v_pk_add_f32 v[50:51], v[50:51], v[58:59]
    v_pk_add_f32 v[52:53], v[52:53], v[60:61]
    v_pk_add_f32 v[54:55], v[54:55], v[62:63]
    v_pk_add_f32 v[32:33], v[32:33], v[48:49]
    v_pk_add_f32 v[34:35], v[34:35], v[50:51]
    v_pk_add_f32 v[36:37], v[36:37], v[52:53]
    v_pk_add_f32 v[38:39], v[38:39], v[54:55]
    v_mul_f32 v32, v32, v249
    v_mul_f32 v33, v33, v249
    v_mul_f32 v34, v34, v249
    v_mul_f32 v35, v35, v249
    v_mul_f32 v36, v36, v249
    v_mul_f32 v37, v37, v249
    v_mul_f32 v38, v38, v249
    v_mul_f32 v39, v39, v249
    v_cvt_pk_bf16_f32 v32, v32, v33
    v_cvt_pk_bf16_f32 v33, v34, v35
    v_cvt_pk_bf16_f32 v34, v36, v37
    v_cvt_pk_bf16_f32 v35, v38, v39
    buffer_store_dwordx4 v[32:35], v239, s[28:31], s97 offen
    s_endpgm
L_A:
    s_load_dwordx2 s[12:13], s[0:1], 8
    s_mov_b32 s14, 0x180000
    s_mov_b32 s15, 0x20000
    s_lshl_b32 s59, s42, 7
    s_add_u32 s57, s59, 1024
    s_and_b32 s43, s43, 3
    s_mul_i32 s51, s40, 49152
    s_add_u32 s52, s51, s57
    v_mul_u32_u24 v252, 3072, v248
    v_add3_u32 v229, v252, v249, s52
    v_add_u32 v230, 23552, v229
    v_add_u32 v231, 1024, v229
    v_add_u32 v232, 24576, v229
    s_waitcnt lgkmcnt(0)
    s_add_u32 m0, s46, 4096
    s_lshl_b32 s44, s43, 7
    s_mul_i32 s45, s43, 196608
    buffer_load_dwordx4 v229, s[12:15], s45 offen lds
    buffer_load_dwordx4 v230, s[12:15], s45 offen offset:1024 lds
    s_add_u32 m0, s46, 6144
    s_nop 0
    buffer_load_dwordx4 v231, s[12:15], s45 offen lds
    buffer_load_dwordx4 v232, s[12:15], s45 offen offset:1024 lds
    s_add_u32 m0, s46, 0
    s_nop 0
    buffer_load_dwordx4 v225, s[8:11], s44 offen lds
    buffer_load_dwordx4 v226, s[8:11], s44 offen offset:1024 lds
    buffer_load_dwordx4 v227, s[8:11], s44 offen offset:2048 lds
    buffer_load_dwordx4 v228, s[8:11], s44 offen offset:3072 lds
    s_add_u32 m0, s46, 36864
    s_add_u32 s43, s43, 1
    s_and_b32 s43, s43, 7
    s_lshl_b32 s44, s43, 7
    s_mul_i32 s45, s43, 196608
    buffer_load_dwordx4 v229, s[12:15], s45 offen lds
    buffer_load_dwordx4 v230, s[12:15], s45 offen offset:1024 lds
    s_add_u32 m0, s46, 38912
    s_nop 0
    buffer_load_dwordx4 v231, s[12:15], s45 offen lds
    buffer_load_dwordx4 v232, s[12:15], s45 offen offset:1024 lds
    s_add_u32 m0, s46, 32768
    s_nop 0
    buffer_load_dwordx4 v225, s[8:11], s44 offen lds
    buffer_load_dwordx4 v226, s[8:11], s44 offen offset:1024 lds
    buffer_load_dwordx4 v227, s[8:11], s44 offen offset:2048 lds
    buffer_load_dwordx4 v228, s[8:11], s44 offen offset:3072 lds
    s_mov_b32 s34, 0x400
    s_mov_b32 s35, 0x20000
    s_and_b32 s98, s42, 4
    s_add_u32 s51, s41, s42
    s_and_b32 s51, s51, 3
    s_add_u32 s51, s51, s98
    s_lshl_b32 s51, s51, 7
    v_lshrrev_b32 v252, 5, v241
    v_lshlrev_b32 v252, 4, v252
    buffer_load_dwordx4 v[192:195], v252, s[32:35], s51 offen offset:0
    buffer_load_dwordx4 v[196:199], v252, s[32:35], s51 offen offset:32
    buffer_load_dwordx4 v[200:203], v252, s[32:35], s51 offen offset:64
    buffer_load_dwordx4 v[204:207], v252, s[32:35], s51 offen offset:96
    s_mov_b32 s26, 0x10000000
    s_mov_b32 s27, 0x20000
    s_mov_b32 s18, 0x1c0000
    s_mov_b32 s19, 0x20000
    s_mov_b32 s22, 0x80000
    s_mov_b32 s23, 0x20000
    s_mov_b32 s30, 0x200000
    s_mov_b32 s31, 0x20000
    s_mov_b32 s38, 0x100
    s_mov_b32 s39, 0x20000
    s_mov_b32 s54, 0x3fb8aa3b
    s_mul_i32 s51, s40, 49152
    s_add_u32 s52, s51, s59
    v_mul_u32_u24 v252, 3072, v248
    v_add3_u32 v208, v252, v249, s52
    v_add_u32 v209, 23552, v208
    s_mul_i32 s52, s40, 28672
    s_lshl_b32 s48, s40, 13
    s_add_u32 s51, s49, 0
    s_and_b32 s51, s51, 3
    s_lshl_b32 s64, s51, 12
    s_add_u32 s64, s64, s52
    s_cmp_ge_u32 s51, 2
    s_cselect_b32 s60, 12288, 0
    s_add_u32 s64, s64, s60
    s_mul_i32 s68, s51, 3072
    s_add_u32 s68, s68, s52
    s_add_u32 s68, s68, 8192
    s_lshl_b32 s72, s51, 11
    s_add_u32 s72, s72, s48
    s_add_u32 s51, s49, 1
    s_and_b32 s51, s51, 3
    s_lshl_b32 s65, s51, 12
    s_add_u32 s65, s65, s52
    s_cmp_ge_u32 s51, 2
    s_cselect_b32 s60, 12288, 0
    s_add_u32 s65, s65, s60
    s_mul_i32 s69, s51, 3072
    s_add_u32 s69, s69, s52
    s_add_u32 s69, s69, 8192
    s_lshl_b32 s73, s51, 11
    s_add_u32 s73, s73, s48
    s_add_u32 s51, s49, 2
    s_and_b32 s51, s51, 3
    s_lshl_b32 s66, s51, 12
    s_add_u32 s66, s66, s52
    s_cmp_ge_u32 s51, 2
    s_cselect_b32 s60, 12288, 0
    s_add_u32 s66, s66, s60
    s_mul_i32 s70, s51, 3072
    s_add_u32 s70, s70, s52
    s_add_u32 s70, s70, 8192
    s_lshl_b32 s74, s51, 11
    s_add_u32 s74, s74, s48
    s_add_u32 s51, s49, 3
    s_and_b32 s51, s51, 3
    s_lshl_b32 s67, s51, 12
    s_add_u32 s67, s67, s52
    s_cmp_ge_u32 s51, 2
    s_cselect_b32 s60, 12288, 0
    s_add_u32 s67, s67, s60
    s_mul_i32 s71, s51, 3072
    s_add_u32 s71, s71, s52
    s_add_u32 s71, s71, 8192
    s_lshl_b32 s75, s51, 11
    s_add_u32 s75, s75, s48
    s_lshl2_add_u32 s49, s55, s49
    s_mul_i32 s86, s49, 229376
    s_lshl_b32 s96, s49, 16
    s_add_u32 s87, s96, 8388608
    s_add_u32 s96, s96, s46
    s_lshl_b32 s51, s50, 7
    s_add_u32 s96, s96, s51
    s_add_u32 s97, s96, 32768
    s_lshl_b32 s88, s49, 11
    s_add_u32 s88, s88, 11599872
    s_lshl_b32 s89, s49, 9
    s_add_u32 s89, s89, 12582912
    s_lshl_b32 s90, s55, 11
    s_lshl_b32 s52, s40, 9
    s_add_u32 s90, s90, s52
    s_add_u32 s90, s90, 12615680
    s_lshl_b32 s52, s40, 1
    s_lshl_b32 s76, 3, s52
    s_mov_b32 s77, s76
    s_lshl_b32 s78, s76, 8
    s_mov_b32 s79, s78
    s_mov_b32 s80, 0xff0000
    s_mov_b32 s81, 0xff0000
    s_or_b64 s[82:83], s[78:79], s[80:81]
    s_or_b64 s[100:101], s[76:77], s[80:81]
    v_lshlrev_b32 v242, 4, v241
    v_lshl_add_u32 v252, v248, 10, v249
    v_add_u32 v233, s51, v252
    v_add_u32 v234, 7168, v233
    v_and_b32 v252, 31, v241
    v_lshrrev_b32 v253, 5, v241
    v_bfe_u32 v254, v241, 1, 3
    v_xor_b32 v254, v253, v254
    v_lshlrev_b32 v254, 4, v254
    v_lshl_add_u32 v254, v252, 7, v254
    v_xor_b32 v255, 0, v254
    v_add_u32 v211, s46, v255
    v_add_u32 v215, 65536, v211
    v_xor_b32 v255, 32, v254
    v_add_u32 v212, s46, v255
    v_add_u32 v216, 65536, v212
    v_xor_b32 v255, 64, v254
    v_add_u32 v213, s46, v255
    v_add_u32 v217, 65536, v213
    v_xor_b32 v255, 96, v254
    v_add_u32 v214, s46, v255
    v_add_u32 v218, 65536, v214
    v_bfe_u32 v252, v241, 2, 2
    v_bfe_u32 v254, v241, 4, 1
    v_lshlrev_b32 v254, 1, v254
    v_bfe_u32 v255, v241, 1, 1
    v_or_b32 v254, v254, v255
    v_bfe_u32 v255, v241, 3, 1
    v_lshl_or_b32 v254, v255, 2, v254
    v_and_b32 v255, 1, v241
    v_lshlrev_b32 v255, 3, v255
    v_lshl_or_b32 v254, v254, 4, v255
    v_lshl_add_u32 v254, v252, 7, v254
    v_lshl_add_u32 v219, v253, 10, v254
    v_xor_b32 v220, 64, v219
    v_add_u32 v221, 65536, v219
    v_add_u32 v222, 65536, v220
    v_lshl_add_u32 v255, v253, 9, v254
    v_add_u32 v235, s46, v255
    v_xor_b32 v236, 64, v235
    v_add_u32 v237, 65536, v235
    v_add_u32 v238, 65536, v236
    v_add_u32 v239, 131072, v235
    v_add_u32 v240, 131072, v236
    s_lshl2_add_u32 s51, s41, s40
    s_lshl_b32 s52, s51, 8
    s_lshl2_add_u32 s52, s42, s52
    s_add_u32 s52, s52, 12582976
    v_mov_b32 v245, s52
    s_lshl_b32 s52, s51, 15
    s_lshl_b32 s60, s42, 12
    s_add_u32 s52, s52, s60
    s_add_u32 s52, s52, 8388608
    v_add_u32 v244, s52, v242
    s_lshl_b32 s63, s51, 10
    s_lshr_b32 s60, s42, 2
    s_lshl_b32 s60, s60, 9
    s_add_u32 s63, s63, s60
    s_and_b32 s60, s42, 3
    s_lshl2_add_u32 s63, s60, s63
    s_add_u32 s63, s63, 11599872
    s_mov_b32 s84, 0xffff
    s_mov_b32 s85, 0xffff
    s_lshr_b32 s51, s40, 1
    s_lshl_b32 s51, s51, 15
    s_and_b32 s52, s40, 1
    s_lshl_b32 s52, s52, 11
    s_add_u32 s51, s51, s52
    s_add_u32 s51, s51, 69632
    v_add_u32 v223, s51, v242
    s_add_u32 s51, s46, 69632
    v_add_u32 v224, s51, v242
    s_lshl4_add_u32 s91, s42, s41
    s_lshl2_add_u32 s95, s91, s40
    s_lshl_b32 s91, s95, 12
    s_add_u32 s91, s91, 14680064
    s_lshl_b32 s95, s95, 2
    s_add_u32 s95, s95, 12615680
    s_and_b32 s60, s41, 3
    s_lshl2_add_u32 s60, s60, s40
    s_lshl_b32 s60, s60, 6
    s_lshr_b32 s51, s41, 2
    s_lshl_b32 s93, s42, 6
    s_add_u32 s93, s93, s51
    s_lshl_b32 s93, s93, 12
    s_add_u32 s93, s93, s60
    s_add_u32 s93, s93, 14680064
    s_add_u32 s92, s93, 131072
    s_lshl2_add_u32 s94, s42, s51
    s_lshl_b32 s94, s94, 10
    s_add_u32 s94, s94, s60
    s_add_u32 s94, s94, 11534336
    v_mov_b32 v248, 0x3f803f80
    v_mov_b32 v249, 0x3f803f80
    v_mov_b32 v250, 0x3f803f80
    v_mov_b32 v251, 0x3f803f80
    s_lshl2_add_u32 s3, s2, s40
    v_lshlrev_b32 v67, 7, v241
    v_and_b32 v68, 0x7ff, v67
    v_and_b32 v69, 0x1ff, v67
    v_and_b32 v67, 0xfff, v67
    s_mul_i32 s99, s3, 1792
    s_lshl_b32 s51, s3, 9
    s_lshl_b32 s52, s3, 11
    s_and_b32 s3, s3, 511
    s_mul_i32 s3, s3, 3072
    buffer_load_dword v65, v68, s[16:19], s99 offen
    buffer_load_dword v65, v69, s[20:23], s51 offen
    v_and_b32 v64, 15, v241
    v_lshlrev_b32 v64, 10, v64
    v_and_b32 v66, 16, v241
    v_lshl_add_u32 v64, v66, 2, v64
    v_and_b32 v66, 0xc40, v64
    s_lshl2_add_u32 s3, s56, s40
    s_mul_i32 s99, s3, 14336
    s_lshl_b32 s3, s3, 12
    s_lshr_b32 s51, s16, 7
    s_sub_u32 s51, 3, s51
    s_and_b32 s51, s51, 7
    s_lshl_b32 s51, s51, 7
    s_add_u32 s99, s99, s51
    s_lshr_b32 s51, s20, 7
    s_sub_u32 s51, 3, s51
    s_and_b32 s51, s51, 7
    s_lshl_b32 s51, s51, 7
    s_add_u32 s3, s3, s51
    v_lshrrev_b32 v70, 2, v241
    v_lshlrev_b32 v70, 10, v70
    v_and_b32 v71, 3, v241
    v_lshl_add_u32 v70, v71, 6, v70
    s_and_b32 s51, s56, 15
    s_lshl2_add_u32 s51, s51, s40
    s_mul_i32 s51, s51, 24576
    s_and_b32 s52, s55, 6
    s_lshl_b32 s52, s52, 7
    s_add_u32 s51, s51, s52
    v_add_u32 v70, s51, v70
    v_add_u32 v71, 8192, v70
    buffer_load_dword v65, v70, s[12:15], 0 offen
    buffer_load_dword v65, v71, s[12:15], 0 offen
    s_waitcnt vmcnt(16)
    s_barrier
    ds_read_b128 a[128:131], v211 offset:0
    ds_read_b64_tr_b16 v[112:113], v219 offset:4096
    ds_read_b64_tr_b16 v[114:115], v219 offset:4608
    ds_read_b64_tr_b16 v[116:117], v220 offset:4096
    ds_read_b64_tr_b16 v[118:119], v220 offset:4608
    ds_read_b64_tr_b16 v[120:121], v219 offset:6144
    ds_read_b64_tr_b16 v[122:123], v219 offset:6656
    ds_read_b64_tr_b16 v[124:125], v220 offset:6144
    ds_read_b64_tr_b16 v[126:127], v220 offset:6656
    ds_read_b128 a[132:135], v212 offset:0
    ds_read_b64_tr_b16 v[128:129], v219 offset:12288
    ds_read_b64_tr_b16 v[130:131], v219 offset:12800
    ds_read_b64_tr_b16 v[132:133], v220 offset:12288
    ds_read_b64_tr_b16 v[134:135], v220 offset:12800
    ds_read_b64_tr_b16 v[136:137], v219 offset:14336
    ds_read_b64_tr_b16 v[138:139], v219 offset:14848
    ds_read_b64_tr_b16 v[140:141], v220 offset:14336
    ds_read_b64_tr_b16 v[142:143], v220 offset:14848
    s_waitcnt lgkmcnt(9)
    v_mfma_f32_32x32x16_bf16 v[0:15], a[128:131], v[112:115], 0
    ds_read_b128 a[136:139], v213 offset:0
    ds_read_b64_tr_b16 v[144:145], v219 offset:20480
    ds_read_b64_tr_b16 v[146:147], v219 offset:20992
    s_add_u32 m0, s46, 69632
    s_add_u32 s43, s43, 1
    s_and_b32 s43, s43, 7
    s_lshl_b32 s44, s43, 7
    s_mul_i32 s45, s43, 196608
    buffer_load_dwordx4 v229, s[12:15], s45 offen lds
    v_mfma_f32_32x32x16_bf16 v[16:31], a[128:131], v[116:119], 0
    ds_read_b64_tr_b16 v[148:149], v220 offset:20480
    ds_read_b64_tr_b16 v[150:151], v220 offset:20992
    buffer_load_dwordx4 v230, s[12:15], s45 offen offset:1024 lds
    v_mfma_f32_32x32x16_bf16 v[32:47], a[128:131], v[120:123], 0
    ds_read_b64_tr_b16 v[152:153], v219 offset:22528
    ds_read_b64_tr_b16 v[154:155], v219 offset:23040
    v_mfma_f32_32x32x16_bf16 v[48:63], a[128:131], v[124:127], 0
    ds_read_b64_tr_b16 v[156:157], v220 offset:22528
    ds_read_b64_tr_b16 v[158:159], v220 offset:23040
    s_waitcnt lgkmcnt(9)
    v_mfma_f32_32x32x16_bf16 v[0:15], a[132:135], v[128:131], v[0:15]
    ds_read_b128 a[140:143], v214 offset:0
    ds_read_b64_tr_b16 v[112:113], v219 offset:28672
    ds_read_b64_tr_b16 v[114:115], v219 offset:29184
    s_add_u32 m0, s46, 71680
    s_nop 0
    buffer_load_dwordx4 v231, s[12:15], s45 offen lds
    v_mfma_f32_32x32x16_bf16 v[16:31], a[132:135], v[132:135], v[16:31]
    ds_read_b64_tr_b16 v[116:117], v220 offset:28672
    ds_read_b64_tr_b16 v[118:119], v220 offset:29184
    v_mfma_f32_32x32x16_bf16 v[32:47], a[132:135], v[136:139], v[32:47]
    ds_read_b64_tr_b16 v[120:121], v219 offset:30720
    ds_read_b64_tr_b16 v[122:123], v219 offset:31232
    buffer_load_dwordx4 v232, s[12:15], s45 offen offset:1024 lds
    v_mfma_f32_32x32x16_bf16 v[48:63], a[132:135], v[140:143], v[48:63]
    ds_read_b64_tr_b16 v[124:125], v220 offset:30720
    ds_read_b64_tr_b16 v[126:127], v220 offset:31232
    s_waitcnt lgkmcnt(9)
    v_mfma_f32_32x32x16_bf16 v[0:15], a[136:139], v[144:147], v[0:15]
    s_waitcnt lgkmcnt(0) vmcnt(12)
    s_barrier
    ds_read_b128 a[144:147], v211 offset:32768
    ds_read_b64_tr_b16 v[128:129], v219 offset:36864
    ds_read_b64_tr_b16 v[130:131], v219 offset:37376
    s_add_u32 m0, s46, 65536
    s_nop 0
    buffer_load_dwordx4 v225, s[8:11], s44 offen lds
    v_mfma_f32_32x32x16_bf16 v[16:31], a[136:139], v[148:151], v[16:31]
    ds_read_b64_tr_b16 v[132:133], v220 offset:36864
    ds_read_b64_tr_b16 v[134:135], v220 offset:37376
    buffer_load_dwordx4 v226, s[8:11], s44 offen offset:1024 lds
    v_mfma_f32_32x32x16_bf16 v[32:47], a[136:139], v[152:155], v[32:47]
    ds_read_b64_tr_b16 v[136:137], v219 offset:38912
    ds_read_b64_tr_b16 v[138:139], v219 offset:39424
    v_mfma_f32_32x32x16_bf16 v[48:63], a[136:139], v[156:159], v[48:63]
    ds_read_b64_tr_b16 v[140:141], v220 offset:38912
    ds_read_b64_tr_b16 v[142:143], v220 offset:39424
    v_mfma_f32_32x32x16_bf16 v[0:15], a[140:143], v[112:115], v[0:15]
    ds_read_b128 a[148:151], v212 offset:32768
    ds_read_b64_tr_b16 v[144:145], v219 offset:45056
    ds_read_b64_tr_b16 v[146:147], v219 offset:45568
    buffer_load_dwordx4 v227, s[8:11], s44 offen offset:2048 lds
    v_mfma_f32_32x32x16_bf16 v[16:31], a[140:143], v[116:119], v[16:31]
    ds_read_b64_tr_b16 v[148:149], v220 offset:45056
    ds_read_b64_tr_b16 v[150:151], v220 offset:45568
    v_mfma_f32_32x32x16_bf16 v[32:47], a[140:143], v[120:123], v[32:47]
    ds_read_b64_tr_b16 v[152:153], v219 offset:47104
    ds_read_b64_tr_b16 v[154:155], v219 offset:47616
    buffer_load_dwordx4 v228, s[8:11], s44 offen offset:3072 lds
    v_mfma_f32_32x32x16_bf16 v[48:63], a[140:143], v[124:127], v[48:63]
    ds_read_b64_tr_b16 v[156:157], v220 offset:47104
    ds_read_b64_tr_b16 v[158:159], v220 offset:47616
    s_waitcnt lgkmcnt(9)
    v_mfma_f32_32x32x16_bf16 v[0:15], a[144:147], v[128:131], v[0:15]
    ds_read_b128 a[152:155], v213 offset:32768
    ds_read_b64_tr_b16 v[112:113], v219 offset:53248
    ds_read_b64_tr_b16 v[114:115], v219 offset:53760
    s_add_u32 m0, s46, 102400
    s_add_u32 s43, s43, 1
    s_and_b32 s43, s43, 7
    s_lshl_b32 s44, s43, 7
    s_mul_i32 s45, s43, 196608
    buffer_load_dwordx4 v229, s[12:15], s45 offen lds
    v_mfma_f32_32x32x16_bf16 v[16:31], a[144:147], v[132:135], v[16:31]
    ds_read_b64_tr_b16 v[116:117], v220 offset:53248
    ds_read_b64_tr_b16 v[118:119], v220 offset:53760
    v_mfma_f32_32x32x16_bf16 v[32:47], a[144:147], v[136:139], v[32:47]
    ds_read_b64_tr_b16 v[120:121], v219 offset:55296
    ds_read_b64_tr_b16 v[122:123], v219 offset:55808
    buffer_load_dwordx4 v230, s[12:15], s45 offen offset:1024 lds
    v_mfma_f32_32x32x16_bf16 v[48:63], a[144:147], v[140:143], v[48:63]
    ds_read_b64_tr_b16 v[124:125], v220 offset:55296
    ds_read_b64_tr_b16 v[126:127], v220 offset:55808
    s_waitcnt lgkmcnt(9)
    v_mfma_f32_32x32x16_bf16 v[0:15], a[148:151], v[144:147], v[0:15]
    ds_read_b128 a[156:159], v214 offset:32768
    ds_read_b64_tr_b16 v[128:129], v219 offset:61440
    ds_read_b64_tr_b16 v[130:131], v219 offset:61952
    s_add_u32 m0, s46, 104448
    s_nop 0
    buffer_load_dwordx4 v231, s[12:15], s45 offen lds
    v_mfma_f32_32x32x16_bf16 v[16:31], a[148:151], v[148:151], v[16:31]
    ds_read_b64_tr_b16 v[132:133], v220 offset:61440
    ds_read_b64_tr_b16 v[134:135], v220 offset:61952
    v_mfma_f32_32x32x16_bf16 v[32:47], a[148:151], v[152:155], v[32:47]
    ds_read_b64_tr_b16 v[136:137], v219 offset:63488
    ds_read_b64_tr_b16 v[138:139], v219 offset:64000
    v_mfma_f32_32x32x16_bf16 v[48:63], a[148:151], v[156:159], v[48:63]
    ds_read_b64_tr_b16 v[140:141], v220 offset:63488
    ds_read_b64_tr_b16 v[142:143], v220 offset:64000
    buffer_load_dwordx4 v232, s[12:15], s45 offen offset:1024 lds
    s_waitcnt lgkmcnt(9)
    v_mfma_f32_32x32x16_bf16 v[0:15], a[152:155], v[112:115], v[0:15]
    s_add_u32 m0, s46, 98304
    s_nop 0
    buffer_load_dwordx4 v225, s[8:11], s44 offen lds
    buffer_load_dwordx4 v226, s[8:11], s44 offen offset:1024 lds
    buffer_load_dwordx4 v227, s[8:11], s44 offen offset:2048 lds
    buffer_load_dwordx4 v228, s[8:11], s44 offen offset:3072 lds
    s_add_u32 m0, s46, 4096
    s_add_u32 s43, s43, 1
    s_and_b32 s43, s43, 7
    s_lshl_b32 s44, s43, 7
    s_mul_i32 s45, s43, 196608
    buffer_load_dwordx4 v229, s[12:15], s45 offen lds
    buffer_load_dwordx4 v230, s[12:15], s45 offen offset:1024 lds
    s_add_u32 m0, s46, 6144
    s_nop 0
    buffer_load_dwordx4 v231, s[12:15], s45 offen lds
    buffer_load_dwordx4 v232, s[12:15], s45 offen offset:1024 lds
    s_add_u32 m0, s46, 0
    s_nop 0
    buffer_load_dwordx4 v225, s[8:11], s44 offen lds
    buffer_load_dwordx4 v226, s[8:11], s44 offen offset:1024 lds
    buffer_load_dwordx4 v227, s[8:11], s44 offen offset:2048 lds
    s_waitcnt lgkmcnt(0) vmcnt(15)
    s_barrier
    ds_read_b128 a[160:163], v215 offset:0
    ds_read_b64_tr_b16 v[144:145], v221 offset:4096
    ds_read_b64_tr_b16 v[146:147], v221 offset:4608
    v_mfma_f32_32x32x16_bf16 v[16:31], a[152:155], v[116:119], v[16:31]
    ds_read_b64_tr_b16 v[148:149], v222 offset:4096
    ds_read_b64_tr_b16 v[150:151], v222 offset:4608
    buffer_load_dwordx4 v228, s[8:11], s44 offen offset:3072 lds
    v_mfma_f32_32x32x16_bf16 v[32:47], a[152:155], v[120:123], v[32:47]
    ds_read_b64_tr_b16 v[152:153], v221 offset:6144
    ds_read_b64_tr_b16 v[154:155], v221 offset:6656
    v_mfma_f32_32x32x16_bf16 v[48:63], a[152:155], v[124:127], v[48:63]
    ds_read_b64_tr_b16 v[156:157], v222 offset:6144
    ds_read_b64_tr_b16 v[158:159], v222 offset:6656
    buffer_load_dword v65, v64, s[16:19], s99 offen
    v_mfma_f32_32x32x16_bf16 v[0:15], a[156:159], v[128:131], v[0:15]
    ds_read_b128 a[164:167], v216 offset:0
    ds_read_b64_tr_b16 v[112:113], v221 offset:12288
    ds_read_b64_tr_b16 v[114:115], v221 offset:12800
    buffer_load_dword v65, v66, s[20:23], s3 offen
    v_mfma_f32_32x32x16_bf16 v[16:31], a[156:159], v[132:135], v[16:31]
    ds_read_b64_tr_b16 v[116:117], v222 offset:12288
    ds_read_b64_tr_b16 v[118:119], v222 offset:12800
    s_add_u32 m0, s46, 36864
    s_add_u32 s43, s43, 1
    s_and_b32 s43, s43, 7
    s_lshl_b32 s44, s43, 7
    s_mul_i32 s45, s43, 196608
    buffer_load_dwordx4 v229, s[12:15], s45 offen lds
    v_mfma_f32_32x32x16_bf16 v[32:47], a[156:159], v[136:139], v[32:47]
    ds_read_b64_tr_b16 v[120:121], v221 offset:14336
    ds_read_b64_tr_b16 v[122:123], v221 offset:14848
    v_mfma_f32_32x32x16_bf16 v[48:63], a[156:159], v[140:143], v[48:63]
    ds_read_b64_tr_b16 v[124:125], v222 offset:14336
    ds_read_b64_tr_b16 v[126:127], v222 offset:14848
    buffer_load_dwordx4 v230, s[12:15], s45 offen offset:1024 lds
    s_waitcnt lgkmcnt(9)
    v_mfma_f32_32x32x16_bf16 v[0:15], a[160:163], v[144:147], v[0:15]
    ds_read_b128 a[168:171], v217 offset:0
    ds_read_b64_tr_b16 v[128:129], v221 offset:20480
    ds_read_b64_tr_b16 v[130:131], v221 offset:20992
    v_mfma_f32_32x32x16_bf16 v[16:31], a[160:163], v[148:151], v[16:31]
    ds_read_b64_tr_b16 v[132:133], v222 offset:20480
    ds_read_b64_tr_b16 v[134:135], v222 offset:20992
    v_mfma_f32_32x32x16_bf16 v[32:47], a[160:163], v[152:155], v[32:47]
    ds_read_b64_tr_b16 v[136:137], v221 offset:22528
    ds_read_b64_tr_b16 v[138:139], v221 offset:23040
    s_add_u32 m0, s46, 38912
    s_nop 0
    buffer_load_dwordx4 v231, s[12:15], s45 offen lds
    v_mfma_f32_32x32x16_bf16 v[48:63], a[160:163], v[156:159], v[48:63]
    ds_read_b64_tr_b16 v[140:141], v222 offset:22528
    ds_read_b64_tr_b16 v[142:143], v222 offset:23040
    s_waitcnt lgkmcnt(9)
    v_mfma_f32_32x32x16_bf16 v[0:15], a[164:167], v[112:115], v[0:15]
    ds_read_b128 a[172:175], v218 offset:0
    ds_read_b64_tr_b16 v[144:145], v221 offset:28672
    ds_read_b64_tr_b16 v[146:147], v221 offset:29184
    buffer_load_dwordx4 v232, s[12:15], s45 offen offset:1024 lds
    v_mfma_f32_32x32x16_bf16 v[16:31], a[164:167], v[116:119], v[16:31]
    ds_read_b64_tr_b16 v[148:149], v222 offset:28672
    ds_read_b64_tr_b16 v[150:151], v222 offset:29184
    v_mfma_f32_32x32x16_bf16 v[32:47], a[164:167], v[120:123], v[32:47]
    ds_read_b64_tr_b16 v[152:153], v221 offset:30720
    ds_read_b64_tr_b16 v[154:155], v221 offset:31232
    s_add_u32 m0, s46, 32768
    s_nop 0
    buffer_load_dwordx4 v225, s[8:11], s44 offen lds
    v_mfma_f32_32x32x16_bf16 v[48:63], a[164:167], v[124:127], v[48:63]
    ds_read_b64_tr_b16 v[156:157], v222 offset:30720
    ds_read_b64_tr_b16 v[158:159], v222 offset:31232
    s_waitcnt lgkmcnt(9)
    v_mfma_f32_32x32x16_bf16 v[0:15], a[168:171], v[128:131], v[0:15]
    buffer_load_dwordx4 v226, s[8:11], s44 offen offset:1024 lds
    buffer_load_dwordx4 v227, s[8:11], s44 offen offset:2048 lds
    s_waitcnt lgkmcnt(0) vmcnt(17)
    s_barrier
    ds_read_b128 a[176:179], v215 offset:32768
    ds_read_b64_tr_b16 v[112:113], v221 offset:36864
    ds_read_b64_tr_b16 v[114:115], v221 offset:37376
    v_mfma_f32_32x32x16_bf16 v[16:31], a[168:171], v[132:135], v[16:31]
    ds_read_b64_tr_b16 v[116:117], v222 offset:36864
    ds_read_b64_tr_b16 v[118:119], v222 offset:37376
    v_mfma_f32_32x32x16_bf16 v[32:47], a[168:171], v[136:139], v[32:47]
    ds_read_b64_tr_b16 v[120:121], v221 offset:38912
    ds_read_b64_tr_b16 v[122:123], v221 offset:39424
    v_mfma_f32_32x32x16_bf16 v[48:63], a[168:171], v[140:143], v[48:63]
    ds_read_b64_tr_b16 v[124:125], v222 offset:38912
    ds_read_b64_tr_b16 v[126:127], v222 offset:39424
    buffer_load_dwordx4 v228, s[8:11], s44 offen offset:3072 lds
    v_mfma_f32_32x32x16_bf16 v[0:15], a[172:175], v[144:147], v[0:15]
    ds_read_b128 a[180:183], v216 offset:32768
    ds_read_b64_tr_b16 v[128:129], v221 offset:45056
    ds_read_b64_tr_b16 v[130:131], v221 offset:45568
    v_mfma_f32_32x32x16_bf16 v[16:31], a[172:175], v[148:151], v[16:31]
    ds_read_b64_tr_b16 v[132:133], v222 offset:45056
    ds_read_b64_tr_b16 v[134:135], v222 offset:45568
    s_add_u32 m0, s46, 69632
    s_add_u32 s43, s43, 1
    s_and_b32 s43, s43, 7
    s_lshl_b32 s44, s43, 7
    s_mul_i32 s45, s43, 196608
    buffer_load_dwordx4 v229, s[12:15], s45 offen lds
    v_mfma_f32_32x32x16_bf16 v[32:47], a[172:175], v[152:155], v[32:47]
    ds_read_b64_tr_b16 v[136:137], v221 offset:47104
    ds_read_b64_tr_b16 v[138:139], v221 offset:47616
    v_mfma_f32_32x32x16_bf16 v[48:63], a[172:175], v[156:159], v[48:63]
    ds_read_b64_tr_b16 v[140:141], v222 offset:47104
    ds_read_b64_tr_b16 v[142:143], v222 offset:47616
    buffer_load_dwordx4 v230, s[12:15], s45 offen offset:1024 lds
    s_waitcnt lgkmcnt(9)
    v_mfma_f32_32x32x16_bf16 v[0:15], a[176:179], v[112:115], v[0:15]
    ds_read_b128 a[184:187], v217 offset:32768
    ds_read_b64_tr_b16 v[144:145], v221 offset:53248
    ds_read_b64_tr_b16 v[146:147], v221 offset:53760
    v_mfma_f32_32x32x16_bf16 v[16:31], a[176:179], v[116:119], v[16:31]
    ds_read_b64_tr_b16 v[148:149], v222 offset:53248
    ds_read_b64_tr_b16 v[150:151], v222 offset:53760
    s_add_u32 m0, s46, 71680
    s_nop 0
    buffer_load_dwordx4 v231, s[12:15], s45 offen lds
    v_mfma_f32_32x32x16_bf16 v[32:47], a[176:179], v[120:123], v[32:47]
    ds_read_b64_tr_b16 v[152:153], v221 offset:55296
    ds_read_b64_tr_b16 v[154:155], v221 offset:55808
    v_mfma_f32_32x32x16_bf16 v[48:63], a[176:179], v[124:127], v[48:63]
    ds_read_b64_tr_b16 v[156:157], v222 offset:55296
    ds_read_b64_tr_b16 v[158:159], v222 offset:55808
    buffer_load_dwordx4 v232, s[12:15], s45 offen offset:1024 lds
    s_waitcnt lgkmcnt(9)
    v_mfma_f32_32x32x16_bf16 v[0:15], a[180:183], v[128:131], v[0:15]
    ds_read_b128 a[188:191], v218 offset:32768
    ds_read_b64_tr_b16 v[112:113], v221 offset:61440
    ds_read_b64_tr_b16 v[114:115], v221 offset:61952
    v_mfma_f32_32x32x16_bf16 v[16:31], a[180:183], v[132:135], v[16:31]
    ds_read_b64_tr_b16 v[116:117], v222 offset:61440
    ds_read_b64_tr_b16 v[118:119], v222 offset:61952
    v_mfma_f32_32x32x16_bf16 v[32:47], a[180:183], v[136:139], v[32:47]
    ds_read_b64_tr_b16 v[120:121], v221 offset:63488
    ds_read_b64_tr_b16 v[122:123], v221 offset:64000
    s_add_u32 m0, s46, 65536
    s_nop 0
    buffer_load_dwordx4 v225, s[8:11], s44 offen lds
    v_mfma_f32_32x32x16_bf16 v[48:63], a[180:183], v[140:143], v[48:63]
    ds_read_b64_tr_b16 v[124:125], v222 offset:63488
    ds_read_b64_tr_b16 v[126:127], v222 offset:64000
    s_waitcnt lgkmcnt(9)
    v_mfma_f32_32x32x16_bf16 v[0:15], a[184:187], v[144:147], v[0:15]
    buffer_load_dwordx4 v226, s[8:11], s44 offen offset:1024 lds
    buffer_load_dwordx4 v227, s[8:11], s44 offen offset:2048 lds
    s_waitcnt lgkmcnt(0) vmcnt(17)
    s_barrier
    ds_read_b128 a[192:195], v211 offset:0
    ds_read_b64_tr_b16 v[128:129], v219 offset:4096
    ds_read_b64_tr_b16 v[130:131], v219 offset:4608
    v_mfma_f32_32x32x16_bf16 v[16:31], a[184:187], v[148:151], v[16:31]
    ds_read_b64_tr_b16 v[132:133], v220 offset:4096
    ds_read_b64_tr_b16 v[134:135], v220 offset:4608
    v_mfma_f32_32x32x16_bf16 v[32:47], a[184:187], v[152:155], v[32:47]
    ds_read_b64_tr_b16 v[136:137], v219 offset:6144
    ds_read_b64_tr_b16 v[138:139], v219 offset:6656
    buffer_load_dwordx4 v228, s[8:11], s44 offen offset:3072 lds
    v_mfma_f32_32x32x16_bf16 v[48:63], a[184:187], v[156:159], v[48:63]
    ds_read_b64_tr_b16 v[140:141], v220 offset:6144
    ds_read_b64_tr_b16 v[142:143], v220 offset:6656
    v_mfma_f32_32x32x16_bf16 v[0:15], a[188:191], v[112:115], v[0:15]
    ds_read_b128 a[196:199], v212 offset:0
    ds_read_b64_tr_b16 v[144:145], v219 offset:12288
    ds_read_b64_tr_b16 v[146:147], v219 offset:12800
    s_add_u32 m0, s46, 102400
    s_add_u32 s43, s43, 1
    s_and_b32 s43, s43, 7
    s_lshl_b32 s44, s43, 7
    s_mul_i32 s45, s43, 196608
    buffer_load_dwordx4 v229, s[12:15], s45 offen lds
    v_mfma_f32_32x32x16_bf16 v[16:31], a[188:191], v[116:119], v[16:31]
    ds_read_b64_tr_b16 v[148:149], v220 offset:12288
    ds_read_b64_tr_b16 v[150:151], v220 offset:12800
    v_mfma_f32_32x32x16_bf16 v[32:47], a[188:191], v[120:123], v[32:47]
    ds_read_b64_tr_b16 v[152:153], v219 offset:14336
    ds_read_b64_tr_b16 v[154:155], v219 offset:14848
    buffer_load_dwordx4 v230, s[12:15], s45 offen offset:1024 lds
    v_mfma_f32_32x32x16_bf16 v[48:63], a[188:191], v[124:127], v[48:63]
    ds_read_b64_tr_b16 v[156:157], v220 offset:14336
    ds_read_b64_tr_b16 v[158:159], v220 offset:14848
    s_waitcnt lgkmcnt(9)
    v_mfma_f32_32x32x16_bf16 v[0:15], a[192:195], v[128:131], v[0:15]
    ds_read_b128 a[200:203], v213 offset:0
    ds_read_b64_tr_b16 v[112:113], v219 offset:20480
    ds_read_b64_tr_b16 v[114:115], v219 offset:20992
    v_mfma_f32_32x32x16_bf16 v[16:31], a[192:195], v[132:135], v[16:31]
    ds_read_b64_tr_b16 v[116:117], v220 offset:20480
    ds_read_b64_tr_b16 v[118:119], v220 offset:20992
    s_add_u32 m0, s46, 104448
    s_nop 0
    buffer_load_dwordx4 v231, s[12:15], s45 offen lds
    v_mfma_f32_32x32x16_bf16 v[32:47], a[192:195], v[136:139], v[32:47]
    ds_read_b64_tr_b16 v[120:121], v219 offset:22528
    ds_read_b64_tr_b16 v[122:123], v219 offset:23040
    v_mfma_f32_32x32x16_bf16 v[48:63], a[192:195], v[140:143], v[48:63]
    ds_read_b64_tr_b16 v[124:125], v220 offset:22528
    ds_read_b64_tr_b16 v[126:127], v220 offset:23040
    buffer_load_dwordx4 v232, s[12:15], s45 offen offset:1024 lds
    s_waitcnt lgkmcnt(9)
    v_mfma_f32_32x32x16_bf16 v[0:15], a[196:199], v[144:147], v[0:15]
    ds_read_b128 a[204:207], v214 offset:0
    ds_read_b64_tr_b16 v[128:129], v219 offset:28672
    ds_read_b64_tr_b16 v[130:131], v219 offset:29184
    v_mfma_f32_32x32x16_bf16 v[16:31], a[196:199], v[148:151], v[16:31]
    ds_read_b64_tr_b16 v[132:133], v220 offset:28672
    ds_read_b64_tr_b16 v[134:135], v220 offset:29184
    s_add_u32 m0, s46, 98304
    s_nop 0
    buffer_load_dwordx4 v225, s[8:11], s44 offen lds
    v_mfma_f32_32x32x16_bf16 v[32:47], a[196:199], v[152:155], v[32:47]
    ds_read_b64_tr_b16 v[136:137], v219 offset:30720
    ds_read_b64_tr_b16 v[138:139], v219 offset:31232
    v_mfma_f32_32x32x16_bf16 v[48:63], a[196:199], v[156:159], v[48:63]
    ds_read_b64_tr_b16 v[140:141], v220 offset:30720
    ds_read_b64_tr_b16 v[142:143], v220 offset:31232
    buffer_load_dwordx4 v226, s[8:11], s44 offen offset:1024 lds
    s_waitcnt lgkmcnt(9)
    v_mfma_f32_32x32x16_bf16 v[0:15], a[200:203], v[112:115], v[0:15]
    buffer_load_dwordx4 v227, s[8:11], s44 offen offset:2048 lds
    s_waitcnt lgkmcnt(0) vmcnt(15)
    s_barrier
    ds_read_b128 a[208:211], v211 offset:32768
    ds_read_b64_tr_b16 v[144:145], v219 offset:36864
    ds_read_b64_tr_b16 v[146:147], v219 offset:37376
    v_mfma_f32_32x32x16_bf16 v[16:31], a[200:203], v[116:119], v[16:31]
    ds_read_b64_tr_b16 v[148:149], v220 offset:36864
    ds_read_b64_tr_b16 v[150:151], v220 offset:37376
    buffer_load_dwordx4 v228, s[8:11], s44 offen offset:3072 lds
    v_add_u32 v225, s86, v242
    v_add_u32 v226, 114688, v225
    v_mfma_f32_32x32x16_bf16 v[32:47], a[200:203], v[120:123], v[32:47]
    ds_read_b64_tr_b16 v[152:153], v219 offset:38912
    ds_read_b64_tr_b16 v[154:155], v219 offset:39424
    v_add_u32 v227, s87, v242
    v_add_u32 v228, 32768, v227
    v_add_u32 v229, 11534336, v242
    v_mfma_f32_32x32x16_bf16 v[48:63], a[200:203], v[124:127], v[48:63]
    ds_read_b64_tr_b16 v[156:157], v220 offset:38912
    ds_read_b64_tr_b16 v[158:159], v220 offset:39424
    s_add_u32 m0, s46, 0
    s_add_u32 s43, s43, 1
    s_and_b32 s43, s43, 7
    s_mul_i32 s45, s43, 196608
    buffer_load_dwordx4 v208, s[12:15], s45 offen lds
    v_mfma_f32_32x32x16_bf16 v[0:15], a[204:207], v[128:131], v[0:15]
    ds_read_b128 a[212:215], v212 offset:32768
    ds_read_b64_tr_b16 v[112:113], v219 offset:45056
    ds_read_b64_tr_b16 v[114:115], v219 offset:45568
    v_lshrrev_b32 v252, 5, v241
    v_and_b32 v231, 31, v241
    v_mfma_f32_32x32x16_bf16 v[16:31], a[204:207], v[132:135], v[16:31]
    ds_read_b64_tr_b16 v[116:117], v220 offset:45056
    ds_read_b64_tr_b16 v[118:119], v220 offset:45568
    v_lshlrev_b32 v231, 2, v231
    buffer_load_dwordx4 v209, s[12:15], s45 offen offset:1024 lds
    v_lshl_add_u32 v231, v252, 8, v231
    v_mfma_f32_32x32x16_bf16 v[32:47], a[204:207], v[136:139], v[32:47]
    ds_read_b64_tr_b16 v[120:121], v219 offset:47104
    ds_read_b64_tr_b16 v[122:123], v219 offset:47616
    v_lshlrev_b32 v232, 3, v241
    buffer_load_dword v243, off, s[36:39], 0 sc1
    v_mfma_f32_32x32x16_bf16 v[48:63], a[204:207], v[140:143], v[48:63]
    ds_read_b64_tr_b16 v[124:125], v220 offset:47104
    ds_read_b64_tr_b16 v[126:127], v220 offset:47616
    s_waitcnt lgkmcnt(9)
    v_mfma_f32_32x32x16_bf16 v[0:15], a[208:211], v[144:147], v[0:15]
    ds_read_b128 a[216:219], v213 offset:32768
    ds_read_b64_tr_b16 v[128:129], v219 offset:53248
    ds_read_b64_tr_b16 v[130:131], v219 offset:53760
    s_add_u32 m0, s46, 2048
    s_add_u32 s43, s43, 1
    s_and_b32 s43, s43, 7
    s_mul_i32 s45, s43, 196608
    buffer_load_dwordx4 v208, s[12:15], s45 offen lds
    v_mfma_f32_32x32x16_bf16 v[16:31], a[208:211], v[148:151], v[16:31]
    ds_read_b64_tr_b16 v[132:133], v220 offset:53248
    ds_read_b64_tr_b16 v[134:135], v220 offset:53760
    v_mfma_f32_32x32x16_bf16 v[32:47], a[208:211], v[152:155], v[32:47]
    ds_read_b64_tr_b16 v[136:137], v219 offset:55296
    ds_read_b64_tr_b16 v[138:139], v219 offset:55808
    buffer_load_dwordx4 v209, s[12:15], s45 offen offset:1024 lds
    v_mfma_f32_32x32x16_bf16 v[48:63], a[208:211], v[156:159], v[48:63]
    ds_read_b64_tr_b16 v[140:141], v220 offset:55296
    ds_read_b64_tr_b16 v[142:143], v220 offset:55808
    s_waitcnt lgkmcnt(9)
    v_mfma_f32_32x32x16_bf16 v[0:15], a[212:215], v[112:115], v[0:15]
    ds_read_b128 a[220:223], v214 offset:32768
    ds_read_b64_tr_b16 v[144:145], v219 offset:61440
    ds_read_b64_tr_b16 v[146:147], v219 offset:61952
    v_mfma_f32_32x32x16_bf16 v[16:31], a[212:215], v[116:119], v[16:31]
    ds_read_b64_tr_b16 v[148:149], v220 offset:61440
    ds_read_b64_tr_b16 v[150:151], v220 offset:61952
    v_mfma_f32_32x32x16_bf16 v[32:47], a[212:215], v[120:123], v[32:47]
    ds_read_b64_tr_b16 v[152:153], v219 offset:63488
    ds_read_b64_tr_b16 v[154:155], v219 offset:64000
    v_mfma_f32_32x32x16_bf16 v[48:63], a[212:215], v[124:127], v[48:63]
    ds_read_b64_tr_b16 v[156:157], v220 offset:63488
    ds_read_b64_tr_b16 v[158:159], v220 offset:64000
    s_waitcnt lgkmcnt(9)
    v_mfma_f32_32x32x16_bf16 v[0:15], a[216:219], v[128:131], v[0:15]
    s_waitcnt lgkmcnt(0) vmcnt(13)
    s_barrier
    ds_read_b128 a[224:227], v215 offset:0
    ds_read_b64_tr_b16 v[112:113], v221 offset:4096
    ds_read_b64_tr_b16 v[114:115], v221 offset:4608
    s_add_u32 m0, s46, 32768
    s_add_u32 s43, s43, 1
    s_and_b32 s43, s43, 7
    s_mul_i32 s45, s43, 196608
    buffer_load_dwordx4 v208, s[12:15], s45 offen lds
    v_mfma_f32_32x32x16_bf16 v[16:31], a[216:219], v[132:135], v[16:31]
    ds_read_b64_tr_b16 v[116:117], v222 offset:4096
    ds_read_b64_tr_b16 v[118:119], v222 offset:4608
    buffer_load_dwordx4 v209, s[12:15], s45 offen offset:1024 lds
    v_mfma_f32_32x32x16_bf16 v[32:47], a[216:219], v[136:139], v[32:47]
    ds_read_b64_tr_b16 v[120:121], v221 offset:6144
    ds_read_b64_tr_b16 v[122:123], v221 offset:6656
    v_mfma_f32_32x32x16_bf16 v[48:63], a[216:219], v[140:143], v[48:63]
    ds_read_b64_tr_b16 v[124:125], v222 offset:6144
    ds_read_b64_tr_b16 v[126:127], v222 offset:6656
    v_mfma_f32_32x32x16_bf16 v[0:15], a[220:223], v[144:147], v[0:15]
    ds_read_b128 a[228:231], v216 offset:0
    ds_read_b64_tr_b16 v[128:129], v221 offset:12288
    ds_read_b64_tr_b16 v[130:131], v221 offset:12800
    s_add_u32 m0, s46, 34816
    s_add_u32 s43, s43, 1
    s_and_b32 s43, s43, 7
    s_mul_i32 s45, s43, 196608
    buffer_load_dwordx4 v208, s[12:15], s45 offen lds
    v_mfma_f32_32x32x16_bf16 v[16:31], a[220:223], v[148:151], v[16:31]
    ds_read_b64_tr_b16 v[132:133], v222 offset:12288
    ds_read_b64_tr_b16 v[134:135], v222 offset:12800
    v_mfma_f32_32x32x16_bf16 v[32:47], a[220:223], v[152:155], v[32:47]
    ds_read_b64_tr_b16 v[136:137], v221 offset:14336
    ds_read_b64_tr_b16 v[138:139], v221 offset:14848
    buffer_load_dwordx4 v209, s[12:15], s45 offen offset:1024 lds
    v_mfma_f32_32x32x16_bf16 v[48:63], a[220:223], v[156:159], v[48:63]
    ds_read_b64_tr_b16 v[140:141], v222 offset:14336
    ds_read_b64_tr_b16 v[142:143], v222 offset:14848
    s_waitcnt lgkmcnt(9)
    v_mfma_f32_32x32x16_bf16 v[0:15], a[224:227], v[112:115], v[0:15]
    ds_read_b128 a[232:235], v217 offset:0
    ds_read_b64_tr_b16 v[144:145], v221 offset:20480
    ds_read_b64_tr_b16 v[146:147], v221 offset:20992
    v_mfma_f32_32x32x16_bf16 v[16:31], a[224:227], v[116:119], v[16:31]
    ds_read_b64_tr_b16 v[148:149], v222 offset:20480
    ds_read_b64_tr_b16 v[150:151], v222 offset:20992
    v_mfma_f32_32x32x16_bf16 v[32:47], a[224:227], v[120:123], v[32:47]
    ds_read_b64_tr_b16 v[152:153], v221 offset:22528
    ds_read_b64_tr_b16 v[154:155], v221 offset:23040
    v_mfma_f32_32x32x16_bf16 v[48:63], a[224:227], v[124:127], v[48:63]
    ds_read_b64_tr_b16 v[156:157], v222 offset:22528
    ds_read_b64_tr_b16 v[158:159], v222 offset:23040
    s_waitcnt lgkmcnt(9)
    v_mfma_f32_32x32x16_bf16 v[0:15], a[228:231], v[128:131], v[0:15]
    ds_read_b128 a[236:239], v218 offset:0
    ds_read_b64_tr_b16 v[112:113], v221 offset:28672
    ds_read_b64_tr_b16 v[114:115], v221 offset:29184
    v_mfma_f32_32x32x16_bf16 v[16:31], a[228:231], v[132:135], v[16:31]
    ds_read_b64_tr_b16 v[116:117], v222 offset:28672
    ds_read_b64_tr_b16 v[118:119], v222 offset:29184
    v_mfma_f32_32x32x16_bf16 v[32:47], a[228:231], v[136:139], v[32:47]
    ds_read_b64_tr_b16 v[120:121], v221 offset:30720
    ds_read_b64_tr_b16 v[122:123], v221 offset:31232
    v_mfma_f32_32x32x16_bf16 v[48:63], a[228:231], v[140:143], v[48:63]
    ds_read_b64_tr_b16 v[124:125], v222 offset:30720
    ds_read_b64_tr_b16 v[126:127], v222 offset:31232
    s_waitcnt lgkmcnt(9)
    v_mfma_f32_32x32x16_bf16 v[0:15], a[232:235], v[144:147], v[0:15]
    s_waitcnt lgkmcnt(0) vmcnt(9)
    s_barrier
    ds_read_b128 a[240:243], v215 offset:32768
    ds_read_b64_tr_b16 v[128:129], v221 offset:36864
    ds_read_b64_tr_b16 v[130:131], v221 offset:37376
    s_add_u32 m0, s46, 65536
    s_add_u32 s43, s43, 1
    s_and_b32 s43, s43, 7
    s_mul_i32 s45, s43, 196608
    buffer_load_dwordx4 v208, s[12:15], s45 offen lds
    v_mfma_f32_32x32x16_bf16 v[16:31], a[232:235], v[148:151], v[16:31]
    ds_read_b64_tr_b16 v[132:133], v222 offset:36864
    ds_read_b64_tr_b16 v[134:135], v222 offset:37376
    buffer_load_dwordx4 v209, s[12:15], s45 offen offset:1024 lds
    v_mfma_f32_32x32x16_bf16 v[32:47], a[232:235], v[152:155], v[32:47]
    ds_read_b64_tr_b16 v[136:137], v221 offset:38912
    ds_read_b64_tr_b16 v[138:139], v221 offset:39424
    v_mfma_f32_32x32x16_bf16 v[48:63], a[232:235], v[156:159], v[48:63]
    ds_read_b64_tr_b16 v[140:141], v222 offset:38912
    ds_read_b64_tr_b16 v[142:143], v222 offset:39424
    s_waitcnt vmcnt(8)
    v_readfirstlane_b32 s47, v243
    s_cmp_eq_u32 s47, 0
    s_cbranch_scc1 L_spin14
L_ok13:
    v_mov_b32 v230, s47
    s_add_u32 m0, s46, 67584
    s_add_u32 s43, s43, 1
    s_and_b32 s43, s43, 7
    s_mul_i32 s45, s43, 196608
    buffer_load_dwordx4 v208, s[12:15], s45 offen lds
    v_mfma_f32_32x32x16_bf16 v[0:15], a[236:239], v[112:115], v[0:15]
    ds_read_b128 a[244:247], v216 offset:32768
    ds_read_b64_tr_b16 v[144:145], v221 offset:45056
    ds_read_b64_tr_b16 v[146:147], v221 offset:45568
    v_mfma_f32_32x32x16_bf16 v[16:31], a[236:239], v[116:119], v[16:31]
    ds_read_b64_tr_b16 v[148:149], v222 offset:45056
    ds_read_b64_tr_b16 v[150:151], v222 offset:45568
    buffer_load_dwordx4 v209, s[12:15], s45 offen offset:1024 lds
    v_mfma_f32_32x32x16_bf16 v[32:47], a[236:239], v[120:123], v[32:47]
    ds_read_b64_tr_b16 v[152:153], v221 offset:47104
    ds_read_b64_tr_b16 v[154:155], v221 offset:47616
    v_mfma_f32_32x32x16_bf16 v[48:63], a[236:239], v[124:127], v[48:63]
    ds_read_b64_tr_b16 v[156:157], v222 offset:47104
    ds_read_b64_tr_b16 v[158:159], v222 offset:47616
    s_waitcnt lgkmcnt(9)
    v_mfma_f32_32x32x16_bf16 v[0:15], a[240:243], v[128:131], v[0:15]
    ds_read_b128 a[248:251], v217 offset:32768
    ds_read_b64_tr_b16 v[112:113], v221 offset:53248
    ds_read_b64_tr_b16 v[114:115], v221 offset:53760
    v_mfma_f32_32x32x16_bf16 v[16:31], a[240:243], v[132:135], v[16:31]
    ds_read_b64_tr_b16 v[116:117], v222 offset:53248
    ds_read_b64_tr_b16 v[118:119], v222 offset:53760
    v_mfma_f32_32x32x16_bf16 v[32:47], a[240:243], v[136:139], v[32:47]
    ds_read_b64_tr_b16 v[120:121], v221 offset:55296
    ds_read_b64_tr_b16 v[122:123], v221 offset:55808
    v_mfma_f32_32x32x16_bf16 v[48:63], a[240:243], v[140:143], v[48:63]
    ds_read_b64_tr_b16 v[124:125], v222 offset:55296
    ds_read_b64_tr_b16 v[126:127], v222 offset:55808
    s_waitcnt lgkmcnt(9)
    v_mfma_f32_32x32x16_bf16 v[0:15], a[244:247], v[144:147], v[0:15]
    ds_read_b128 a[252:255], v218 offset:32768
    ds_read_b64_tr_b16 v[128:129], v221 offset:61440
    ds_read_b64_tr_b16 v[130:131], v221 offset:61952
    v_mfma_f32_32x32x16_bf16 v[16:31], a[244:247], v[148:151], v[16:31]
    ds_read_b64_tr_b16 v[132:133], v222 offset:61440
    ds_read_b64_tr_b16 v[134:135], v222 offset:61952
    v_mfma_f32_32x32x16_bf16 v[32:47], a[244:247], v[152:155], v[32:47]
    ds_read_b64_tr_b16 v[136:137], v221 offset:63488
    ds_read_b64_tr_b16 v[138:139], v221 offset:64000
    v_mfma_f32_32x32x16_bf16 v[48:63], a[244:247], v[156:159], v[48:63]
    ds_read_b64_tr_b16 v[140:141], v222 offset:63488
    ds_read_b64_tr_b16 v[142:143], v222 offset:64000
    s_waitcnt lgkmcnt(9)
    v_mfma_f32_32x32x16_bf16 v[0:15], a[248:251], v[112:115], v[0:15]
    s_waitcnt lgkmcnt(0) vmcnt(8)
    s_barrier
    ds_read_b64_tr_b16 v[144:145], v219 offset:0
    s_add_u32 m0, s46, 98304
    s_add_u32 s43, s43, 1
    s_and_b32 s43, s43, 7
    s_mul_i32 s45, s43, 196608
    buffer_load_dwordx4 v208, s[12:15], s45 offen lds
    v_mfma_f32_32x32x16_bf16 v[16:31], a[248:251], v[116:119], v[16:31]
    ds_read_b64_tr_b16 v[146:147], v219 offset:512
    v_mfma_f32_32x32x16_bf16 v[32:47], a[248:251], v[120:123], v[32:47]
    ds_read_b64_tr_b16 v[148:149], v220 offset:0
    buffer_load_dwordx4 v209, s[12:15], s45 offen offset:1024 lds
    v_mfma_f32_32x32x16_bf16 v[48:63], a[248:251], v[124:127], v[48:63]
    ds_read_b64_tr_b16 v[150:151], v220 offset:512
    v_mfma_f32_32x32x16_bf16 v[0:15], a[252:255], v[128:131], v[0:15]
    ds_read_b64_tr_b16 v[112:113], v219 offset:8192
    s_add_u32 m0, s46, 100352
    s_add_u32 s43, s43, 1
    s_and_b32 s43, s43, 7
    s_mul_i32 s45, s43, 196608
    buffer_load_dwordx4 v208, s[12:15], s45 offen lds
    v_mfma_f32_32x32x16_bf16 v[16:31], a[252:255], v[132:135], v[16:31]
    ds_read_b64_tr_b16 v[114:115], v219 offset:8704
    v_lshrrev_b32 v212, 3, v241
    v_lshlrev_b32 v212, 14, v212
    v_bfe_u32 v214, v241, 2, 1
    v_lshl_add_u32 v212, v214, 11, v212
    v_mfma_f32_32x32x16_bf16 v[32:47], a[252:255], v[136:139], v[32:47]
    ds_read_b64_tr_b16 v[116:117], v220 offset:8192
    buffer_load_dwordx4 v209, s[12:15], s45 offen offset:1024 lds
    v_and_b32 v213, 48, v242
    v_add_u32 v212, v212, v213
    v_lshl_add_u32 v213, v214, 3, v213
    v_mfma_f32_32x32x16_bf16 v[48:63], a[252:255], v[140:143], v[48:63]
    ds_read_b64_tr_b16 v[118:119], v220 offset:8704
    v_and_b32 v214, 7, v241
    v_lshlrev_b32 v214, 11, v214
    s_cmp_lg_u32 s98, 0
    s_cbranch_scc1 L_gl17
    v_mfma_f32_32x32x16_bf16 v[96:111], v[192:195], a[128:131], 0
    v_mfma_f32_32x32x16_bf16 v[96:111], v[196:199], a[132:135], v[96:111]
    v_mfma_f32_32x32x16_bf16 v[96:111], v[200:203], a[136:139], v[96:111]
    v_mfma_f32_32x32x16_bf16 v[96:111], v[204:207], a[140:143], v[96:111]
    s_branch L_gj16
L_gl17:
    v_mfma_f32_32x32x16_bf16 v[96:111], v[192:195], a[192:195], 0
    v_mfma_f32_32x32x16_bf16 v[96:111], v[196:199], a[196:199], v[96:111]
    v_mfma_f32_32x32x16_bf16 v[96:111], v[200:203], a[200:203], v[96:111]
    v_mfma_f32_32x32x16_bf16 v[96:111], v[204:207], a[204:207], v[96:111]
L_gj16:
    s_waitcnt lgkmcnt(4)
    v_mfma_f32_32x32x16_bf16 v[64:79], v[144:147], a[128:131], 0
    ds_read_b64_tr_b16 v[128:129], v219 offset:16384
    ds_read_b64_tr_b16 v[130:131], v219 offset:16896
    v_mfma_f32_32x32x16_bf16 v[80:95], v[148:151], a[128:131], 0
    ds_read_b64_tr_b16 v[132:133], v220 offset:16384
    ds_read_b64_tr_b16 v[134:135], v220 offset:16896
    s_add_u32 m0, s46, 131072
    s_lshl4_add_u32 s48, s64, 0
    buffer_load_dwordx4 v233, s[16:19], s48 offen lds
    v_and_b32 v252, 0x1f0, v242
    s_nop 0
    buffer_store_dword v96, v252, s[24:27], s63 offen sc1
    v_mul_f32 v120, s54, v0
    v_mul_f32 v121, s54, v1
    v_mul_f32 v122, s54, v2
    v_mul_f32 v123, s54, v3
    v_mul_f32 v124, s54, v4
    v_mul_f32 v125, s54, v5
    v_mul_f32 v126, s54, v6
    v_mul_f32 v127, s54, v7
    v_exp_f32_e64 v120, v120 clamp
    v_exp_f32_e64 v121, v121 clamp
    v_exp_f32_e64 v122, v122 clamp
    v_exp_f32_e64 v123, v123 clamp
    v_exp_f32_e64 v124, v124 clamp
    s_waitcnt lgkmcnt(4)
    v_mfma_f32_32x32x16_bf16 v[64:79], v[112:115], a[132:135], v[64:79]
    ds_read_b64_tr_b16 v[144:145], v219 offset:24576
    ds_read_b64_tr_b16 v[146:147], v219 offset:25088
    buffer_load_dwordx4 v234, s[16:19], s48 offen offset:1024 lds
    v_exp_f32_e64 v125, v125 clamp
    v_exp_f32_e64 v126, v126 clamp
    v_exp_f32_e64 v127, v127 clamp
    v_max_f32 v0, 0x358637bd, v0
    v_max_f32 v1, 0x358637bd, v1
    v_max_f32 v2, 0x358637bd, v2
    v_max_f32 v3, 0x358637bd, v3
    v_max_f32 v4, 0x358637bd, v4
    v_max_f32 v5, 0x358637bd, v5
    v_max_f32 v6, 0x358637bd, v6
    v_max_f32 v7, 0x358637bd, v7
    v_add_f32 v0, v0, v120
    v_add_f32 v1, v1, v121
    v_add_f32 v2, v2, v122
    v_add_f32 v3, v3, v123
    v_add_f32 v4, v4, v124
    v_add_f32 v5, v5, v125
    v_mfma_f32_32x32x16_bf16 v[80:95], v[116:119], a[132:135], v[80:95]
    ds_read_b64_tr_b16 v[148:149], v220 offset:24576
    ds_read_b64_tr_b16 v[150:151], v220 offset:25088
    s_add_u32 m0, s46, 133120
    s_lshl4_add_u32 s48, s64, 16384
    buffer_load_dwordx4 v233, s[16:19], s48 offen lds
    v_add_f32 v6, v6, v126
    v_add_f32 v7, v7, v127
    v_cvt_pk_bf16_f32 v0, v0, v1
    v_cvt_pk_bf16_f32 v1, v2, v3
    v_cvt_pk_bf16_f32 v2, v4, v5
    v_cvt_pk_bf16_f32 v3, v6, v7
    v_cvt_pk_bf16_f32 v32, v32, v33
    v_cvt_pk_bf16_f32 v33, v34, v35
    v_cvt_pk_bf16_f32 v34, v36, v37
    v_cvt_pk_bf16_f32 v35, v38, v39
    v_mul_f32 v136, s54, v8
    v_mul_f32 v137, s54, v9
    v_mul_f32 v138, s54, v10
    v_mul_f32 v139, s54, v11
    v_mul_f32 v140, s54, v12
    v_mul_f32 v141, s54, v13
    v_mul_f32 v142, s54, v14
    v_mul_f32 v143, s54, v15
    v_exp_f32_e64 v136, v136 clamp
    s_waitcnt lgkmcnt(4)
    v_mfma_f32_32x32x16_bf16 v[64:79], v[128:131], a[136:139], v[64:79]
    ds_read_b64_tr_b16 v[112:113], v219 offset:2048
    ds_read_b64_tr_b16 v[114:115], v219 offset:2560
    buffer_load_dwordx4 v234, s[16:19], s48 offen offset:1024 lds
    v_exp_f32_e64 v137, v137 clamp
    v_exp_f32_e64 v138, v138 clamp
    v_exp_f32_e64 v139, v139 clamp
    v_exp_f32_e64 v140, v140 clamp
    v_exp_f32_e64 v141, v141 clamp
    v_exp_f32_e64 v142, v142 clamp
    v_exp_f32_e64 v143, v143 clamp
    v_max_f32 v8, 0x358637bd, v8
    v_max_f32 v9, 0x358637bd, v9
    v_max_f32 v10, 0x358637bd, v10
    v_max_f32 v11, 0x358637bd, v11
    v_max_f32 v12, 0x358637bd, v12
    v_max_f32 v13, 0x358637bd, v13
    v_mfma_f32_32x32x16_bf16 v[80:95], v[132:135], a[136:139], v[80:95]
    ds_read_b64_tr_b16 v[116:117], v220 offset:2048
    ds_read_b64_tr_b16 v[118:119], v220 offset:2560
    s_add_u32 m0, s46, 135168
    s_lshl4_add_u32 s48, s64, 32768
    buffer_load_dwordx4 v233, s[16:19], s48 offen lds
    v_max_f32 v14, 0x358637bd, v14
    v_max_f32 v15, 0x358637bd, v15
    v_add_f32 v8, v8, v136
    v_add_f32 v9, v9, v137
    v_add_f32 v10, v10, v138
    v_add_f32 v11, v11, v139
    v_add_f32 v12, v12, v140
    v_add_f32 v13, v13, v141
    v_add_f32 v14, v14, v142
    v_add_f32 v15, v15, v143
    v_cvt_pk_bf16_f32 v8, v8, v9
    v_cvt_pk_bf16_f32 v9, v10, v11
    v_cvt_pk_bf16_f32 v10, v12, v13
    v_cvt_pk_bf16_f32 v11, v14, v15
    v_cvt_pk_bf16_f32 v40, v40, v41
    v_cvt_pk_bf16_f32 v41, v42, v43
    v_cvt_pk_bf16_f32 v42, v44, v45
    v_cvt_pk_bf16_f32 v43, v46, v47
    v_mfma_f32_32x32x16_bf16 v[160:175], v[0:3], v[32:35], 0
    v_mfma_f32_32x32x16_bf16 v[192:207], v[0:3], v[248:251], 0
    v_mfma_f32_32x32x16_bf16 v[160:175], v[8:11], v[40:43], v[160:175]
    v_mfma_f32_32x32x16_bf16 v[192:207], v[8:11], v[248:251], v[192:207]
    v_mul_f32 v120, s54, v16
    v_mul_f32 v121, s54, v17
    v_mul_f32 v122, s54, v18
    v_mul_f32 v123, s54, v19
    v_mul_f32 v124, s54, v20
    s_waitcnt lgkmcnt(4)
    v_mfma_f32_32x32x16_bf16 v[64:79], v[144:147], a[140:143], v[64:79]
    ds_read_b64_tr_b16 v[128:129], v219 offset:10240
    ds_read_b64_tr_b16 v[130:131], v219 offset:10752
    buffer_load_dwordx4 v234, s[16:19], s48 offen offset:1024 lds
    v_mul_f32 v125, s54, v21
    v_mul_f32 v126, s54, v22
    v_mul_f32 v127, s54, v23
    v_exp_f32_e64 v120, v120 clamp
    v_exp_f32_e64 v121, v121 clamp
    v_exp_f32_e64 v122, v122 clamp
    v_exp_f32_e64 v123, v123 clamp
    v_exp_f32_e64 v124, v124 clamp
    v_exp_f32_e64 v125, v125 clamp
    v_exp_f32_e64 v126, v126 clamp
    v_exp_f32_e64 v127, v127 clamp
    v_max_f32 v16, 0x358637bd, v16
    v_mfma_f32_32x32x16_bf16 v[80:95], v[148:151], a[140:143], v[80:95]
    ds_read_b64_tr_b16 v[132:133], v220 offset:10240
    ds_read_b64_tr_b16 v[134:135], v220 offset:10752
    s_add_u32 m0, s46, 137216
    s_lshl4_add_u32 s48, s64, 49152
    buffer_load_dwordx4 v233, s[16:19], s48 offen lds
    v_max_f32 v17, 0x358637bd, v17
    v_max_f32 v18, 0x358637bd, v18
    v_max_f32 v19, 0x358637bd, v19
    v_max_f32 v20, 0x358637bd, v20
    v_max_f32 v21, 0x358637bd, v21
    v_max_f32 v22, 0x358637bd, v22
    v_max_f32 v23, 0x358637bd, v23
    v_add_f32 v16, v16, v120
    v_add_f32 v17, v17, v121
    v_add_f32 v18, v18, v122
    v_add_f32 v19, v19, v123
    v_add_f32 v20, v20, v124
    v_add_f32 v21, v21, v125
    v_add_f32 v22, v22, v126
    v_add_f32 v23, v23, v127
    v_cvt_pk_bf16_f32 v16, v16, v17
    v_cvt_pk_bf16_f32 v17, v18, v19
    v_cvt_pk_bf16_f32 v18, v20, v21
    v_cvt_pk_bf16_f32 v19, v22, v23
    v_cvt_pk_bf16_f32 v48, v48, v49
    s_waitcnt lgkmcnt(4)
    v_mfma_f32_32x32x16_bf16 v[64:79], v[112:115], a[144:147], v[64:79]
    ds_read_b64_tr_b16 v[144:145], v219 offset:18432
    ds_read_b64_tr_b16 v[146:147], v219 offset:18944
    buffer_load_dwordx4 v234, s[16:19], s48 offen offset:1024 lds
    v_cvt_pk_bf16_f32 v49, v50, v51
    v_cvt_pk_bf16_f32 v50, v52, v53
    v_cvt_pk_bf16_f32 v51, v54, v55
    v_mul_f32 v136, s54, v24
    v_mul_f32 v137, s54, v25
    v_mul_f32 v138, s54, v26
    v_mul_f32 v139, s54, v27
    v_mul_f32 v140, s54, v28
    v_mul_f32 v141, s54, v29
    v_mul_f32 v142, s54, v30
    v_mul_f32 v143, s54, v31
    v_exp_f32_e64 v136, v136 clamp
    v_exp_f32_e64 v137, v137 clamp
    v_exp_f32_e64 v138, v138 clamp
    v_exp_f32_e64 v139, v139 clamp
    v_exp_f32_e64 v140, v140 clamp
    v_mfma_f32_32x32x16_bf16 v[80:95], v[116:119], a[144:147], v[80:95]
    ds_read_b64_tr_b16 v[148:149], v220 offset:18432
    ds_read_b64_tr_b16 v[150:151], v220 offset:18944
    s_add_u32 m0, s46, 4096
    s_lshl4_add_u32 s48, s65, 0
    buffer_load_dwordx4 v233, s[16:19], s48 offen lds
    v_exp_f32_e64 v141, v141 clamp
    v_exp_f32_e64 v142, v142 clamp
    v_exp_f32_e64 v143, v143 clamp
    v_max_f32 v24, 0x358637bd, v24
    v_max_f32 v25, 0x358637bd, v25
    v_max_f32 v26, 0x358637bd, v26
    v_max_f32 v27, 0x358637bd, v27
    v_max_f32 v28, 0x358637bd, v28
    v_max_f32 v29, 0x358637bd, v29
    v_max_f32 v30, 0x358637bd, v30
    v_max_f32 v31, 0x358637bd, v31
    v_add_f32 v24, v24, v136
    v_add_f32 v25, v25, v137
    v_add_f32 v26, v26, v138
    v_add_f32 v27, v27, v139
    v_add_f32 v28, v28, v140
    v_add_f32 v29, v29, v141
    s_waitcnt lgkmcnt(4)
    v_mfma_f32_32x32x16_bf16 v[64:79], v[128:131], a[148:151], v[64:79]
    ds_read_b64_tr_b16 v[112:113], v219 offset:26624
    ds_read_b64_tr_b16 v[114:115], v219 offset:27136
    buffer_load_dwordx4 v234, s[16:19], s48 offen offset:1024 lds
    v_add_f32 v30, v30, v142
    v_add_f32 v31, v31, v143
    v_cvt_pk_bf16_f32 v24, v24, v25
    v_cvt_pk_bf16_f32 v25, v26, v27
    v_cvt_pk_bf16_f32 v26, v28, v29
    v_cvt_pk_bf16_f32 v27, v30, v31
    v_cvt_pk_bf16_f32 v56, v56, v57
    v_cvt_pk_bf16_f32 v57, v58, v59
    v_cvt_pk_bf16_f32 v58, v60, v61
    v_cvt_pk_bf16_f32 v59, v62, v63
    v_mfma_f32_32x32x16_bf16 v[176:191], v[16:19], v[48:51], 0
    v_mfma_f32_32x32x16_bf16 v[96:111], v[16:19], v[248:251], 0
    v_mfma_f32_32x32x16_bf16 v[176:191], v[24:27], v[56:59], v[176:191]
    v_mfma_f32_32x32x16_bf16 v[96:111], v[24:27], v[248:251], v[96:111]
    v_cndmask_b32 v160, v192, v160, s[84:85]
    v_cndmask_b32 v161, v193, v161, s[84:85]
    v_cndmask_b32 v162, v194, v162, s[84:85]
    v_cndmask_b32 v163, v195, v163, s[84:85]
    v_cndmask_b32 v164, v196, v164, s[84:85]
    v_mfma_f32_32x32x16_bf16 v[80:95], v[132:135], a[148:151], v[80:95]
    ds_read_b64_tr_b16 v[116:117], v220 offset:26624
    ds_read_b64_tr_b16 v[118:119], v220 offset:27136
    s_add_u32 m0, s46, 6144
    s_lshl4_add_u32 s48, s65, 16384
    buffer_load_dwordx4 v233, s[16:19], s48 offen lds
    v_cndmask_b32 v165, v197, v165, s[84:85]
    v_cndmask_b32 v166, v198, v166, s[84:85]
    v_cndmask_b32 v167, v199, v167, s[84:85]
    v_cndmask_b32 v168, v168, v200, s[84:85]
    v_cndmask_b32 v169, v169, v201, s[84:85]
    v_cndmask_b32 v170, v170, v202, s[84:85]
    v_cndmask_b32 v171, v171, v203, s[84:85]
    v_cndmask_b32 v172, v172, v204, s[84:85]
    v_cndmask_b32 v173, v173, v205, s[84:85]
    v_cndmask_b32 v174, v174, v206, s[84:85]
    v_cndmask_b32 v175, v175, v207, s[84:85]
    ds_write_b128 v223, v[160:163] offset:0
    ds_write_b128 v223, v[164:167] offset:1024
    ds_write_b128 v223, v[168:171] offset:8192
    ds_write_b128 v223, v[172:175] offset:9216
    v_cndmask_b32 v176, v96, v176, s[84:85]
    v_cndmask_b32 v177, v97, v177, s[84:85]
    v_cndmask_b32 v178, v98, v178, s[84:85]
    v_cndmask_b32 v179, v99, v179, s[84:85]
    v_cndmask_b32 v180, v100, v180, s[84:85]
    s_waitcnt lgkmcnt(8)
    v_mfma_f32_32x32x16_bf16 v[64:79], v[144:147], a[152:155], v[64:79]
    s_waitcnt lgkmcnt(4) vmcnt(20)
    s_barrier
    ds_read_b64_tr_b16 v[128:129], v219 offset:32768
    ds_read_b64_tr_b16 v[130:131], v219 offset:33280
    buffer_load_dwordx4 v234, s[16:19], s48 offen offset:1024 lds
    v_cndmask_b32 v181, v101, v181, s[84:85]
    v_cndmask_b32 v182, v102, v182, s[84:85]
    v_cndmask_b32 v183, v103, v183, s[84:85]
    v_cndmask_b32 v184, v184, v104, s[84:85]
    v_cndmask_b32 v185, v185, v105, s[84:85]
    v_cndmask_b32 v186, v186, v106, s[84:85]
    v_cndmask_b32 v187, v187, v107, s[84:85]
    v_cndmask_b32 v188, v188, v108, s[84:85]
    v_cndmask_b32 v189, v189, v109, s[84:85]
    v_cndmask_b32 v190, v190, v110, s[84:85]
    v_cndmask_b32 v191, v191, v111, s[84:85]
    ds_write_b128 v223, v[176:179] offset:16384
    ds_write_b128 v223, v[180:183] offset:17408
    ds_write_b128 v223, v[184:187] offset:24576
    ds_write_b128 v223, v[188:191] offset:25600
    v_mfma_f32_32x32x16_bf16 v[80:95], v[148:151], a[152:155], v[80:95]
    ds_read_b64_tr_b16 v[132:133], v220 offset:32768
    ds_read_b64_tr_b16 v[134:135], v220 offset:33280
    s_add_u32 m0, s46, 36864
    s_lshl4_add_u32 s48, s65, 32768
    buffer_load_dwordx4 v233, s[16:19], s48 offen lds
    v_mfma_f32_32x32x16_bf16 v[64:79], v[112:115], a[156:159], v[64:79]
    ds_read_b64_tr_b16 v[144:145], v219 offset:40960
    ds_read_b64_tr_b16 v[146:147], v219 offset:41472
    buffer_load_dwordx4 v234, s[16:19], s48 offen offset:1024 lds
    v_mfma_f32_32x32x16_bf16 v[80:95], v[116:119], a[156:159], v[80:95]
    ds_read_b64_tr_b16 v[148:149], v220 offset:40960
    ds_read_b64_tr_b16 v[150:151], v220 offset:41472
    s_waitcnt lgkmcnt(4)
    v_mfma_f32_32x32x16_bf16 v[64:79], v[128:131], a[160:163], v[64:79]
    ds_read_b64_tr_b16 v[112:113], v219 offset:49152
    ds_read_b64_tr_b16 v[114:115], v219 offset:49664
    s_barrier
    ds_read_b128 v[160:163], v224 offset:0
    ds_read_b128 v[164:167], v224 offset:1024
    ds_read_b128 v[168:171], v224 offset:2048
    ds_read_b128 v[172:175], v224 offset:3072
    ds_read_b128 v[176:179], v224 offset:32768
    ds_read_b128 v[180:183], v224 offset:33792
    ds_read_b128 v[184:187], v224 offset:34816
    ds_read_b128 v[188:191], v224 offset:35840
    s_add_u32 m0, s46, 38912
    s_lshl4_add_u32 s48, s65, 49152
    buffer_load_dwordx4 v233, s[16:19], s48 offen lds
    v_mfma_f32_32x32x16_bf16 v[80:95], v[132:135], a[160:163], v[80:95]
    ds_read_b64_tr_b16 v[116:117], v220 offset:49152
    ds_read_b64_tr_b16 v[118:119], v220 offset:49664
    buffer_load_dwordx4 v234, s[16:19], s48 offen offset:1024 lds
    s_waitcnt lgkmcnt(12)
    v_mfma_f32_32x32x16_bf16 v[64:79], v[144:147], a[164:167], v[64:79]
    ds_read_b64_tr_b16 v[128:129], v219 offset:57344
    ds_read_b64_tr_b16 v[130:131], v219 offset:57856
    v_mfma_f32_32x32x16_bf16 v[80:95], v[148:151], a[164:167], v[80:95]
    ds_read_b64_tr_b16 v[132:133], v220 offset:57344
    ds_read_b64_tr_b16 v[134:135], v220 offset:57856
    s_waitcnt lgkmcnt(4)
    v_mfma_f32_32x32x16_bf16 v[64:79], v[112:115], a[168:171], v[64:79]
    ds_read_b64_tr_b16 v[144:145], v219 offset:34816
    ds_read_b64_tr_b16 v[146:147], v219 offset:35328
    v_add_f32 v160, v160, v168
    v_add_f32 v161, v161, v169
    s_add_u32 m0, s46, 69632
    s_lshl4_add_u32 s48, s66, 0
    buffer_load_dwordx4 v233, s[16:19], s48 offen lds
    v_add_f32 v162, v162, v170
    v_add_f32 v163, v163, v171
    v_add_f32 v164, v164, v172
    v_add_f32 v165, v165, v173
    v_add_f32 v166, v166, v174
    v_add_f32 v167, v167, v175
    v_add_f32 v176, v176, v184
    v_add_f32 v177, v177, v185
    v_add_f32 v178, v178, v186
    v_add_f32 v179, v179, v187
    v_add_f32 v180, v180, v188
    v_add_f32 v181, v181, v189
    v_add_f32 v182, v182, v190
    v_add_f32 v183, v183, v191
    v_mov_b32 v193, v230
    v_mov_b32 v195, v230
    v_mov_b32 v197, v230
    v_mov_b32 v199, v230
    v_mfma_f32_32x32x16_bf16 v[80:95], v[116:119], a[168:171], v[80:95]
    ds_read_b64_tr_b16 v[148:149], v220 offset:34816
    ds_read_b64_tr_b16 v[150:151], v220 offset:35328
    buffer_load_dwordx4 v234, s[16:19], s48 offen offset:1024 lds
    v_mov_b32 v201, v230
    v_mov_b32 v203, v230
    v_mov_b32 v205, v230
    v_mov_b32 v207, v230
    v_add_f32 v192, v160, v176
    v_add_f32 v194, v161, v177
    v_add_f32 v196, v162, v178
    v_add_f32 v198, v163, v179
    v_add_f32 v200, v164, v180
    v_add_f32 v202, v165, v181
    v_add_f32 v204, v166, v182
    v_add_f32 v206, v167, v183
    buffer_store_dwordx4 v[192:195], v242, s[24:27], s91 offen offset:0 sc1
    buffer_store_dwordx4 v[196:199], v242, s[24:27], s91 offen offset:1024 sc1
    buffer_store_dwordx4 v[200:203], v242, s[24:27], s91 offen offset:2048 sc1
    s_waitcnt lgkmcnt(4)
    v_mfma_f32_32x32x16_bf16 v[64:79], v[128:131], a[172:175], v[64:79]
    ds_read_b64_tr_b16 v[112:113], v219 offset:43008
    ds_read_b64_tr_b16 v[114:115], v219 offset:43520
    buffer_store_dwordx4 v[204:207], v242, s[24:27], s91 offen offset:3072 sc1
    v_mfma_f32_32x32x16_bf16 v[80:95], v[132:135], a[172:175], v[80:95]
    ds_read_b64_tr_b16 v[116:117], v220 offset:43008
    ds_read_b64_tr_b16 v[118:119], v220 offset:43520
    s_waitcnt lgkmcnt(4)
    v_mfma_f32_32x32x16_bf16 v[64:79], v[144:147], a[176:179], v[64:79]
    ds_read_b64_tr_b16 v[128:129], v219 offset:51200
    ds_read_b64_tr_b16 v[130:131], v219 offset:51712
    v_mfma_f32_32x32x16_bf16 v[80:95], v[148:151], a[176:179], v[80:95]
    ds_read_b64_tr_b16 v[132:133], v220 offset:51200
    ds_read_b64_tr_b16 v[134:135], v220 offset:51712
    s_waitcnt lgkmcnt(4)
    v_mfma_f32_32x32x16_bf16 v[64:79], v[112:115], a[180:183], v[64:79]
    ds_read_b64_tr_b16 v[144:145], v219 offset:59392
    ds_read_b64_tr_b16 v[146:147], v219 offset:59904
    s_add_u32 m0, s46, 71680
    s_lshl4_add_u32 s48, s66, 16384
    buffer_load_dwordx4 v233, s[16:19], s48 offen lds
    v_mfma_f32_32x32x16_bf16 v[80:95], v[116:119], a[180:183], v[80:95]
    ds_read_b64_tr_b16 v[148:149], v220 offset:59392
    ds_read_b64_tr_b16 v[150:151], v220 offset:59904
    buffer_load_dwordx4 v234, s[16:19], s48 offen offset:1024 lds
    s_waitcnt lgkmcnt(4)
    v_mfma_f32_32x32x16_bf16 v[64:79], v[128:131], a[184:187], v[64:79]
    s_waitcnt lgkmcnt(0) vmcnt(29)
    s_barrier
    ds_read_b64_tr_b16 v[112:113], v221 offset:0
    ds_read_b64_tr_b16 v[114:115], v221 offset:512
    ds_read_b64_tr_b16 v[116:117], v221 offset:8192
    ds_read_b64_tr_b16 v[118:119], v221 offset:8704
    s_add_u32 m0, s46, 102400
    s_lshl4_add_u32 s48, s66, 32768
    buffer_load_dwordx4 v233, s[16:19], s48 offen lds
    s_waitcnt vmcnt(23)
    ds_read_b64_tr_b16 a[0:1], v239 offset:0
    ds_read_b64_tr_b16 a[4:5], v240 offset:0
    ds_read_b64_tr_b16 a[2:3], v239 offset:1024
    ds_read_b64_tr_b16 a[6:7], v240 offset:1024
    v_mfma_f32_32x32x16_bf16 v[80:95], v[132:135], a[184:187], v[80:95]
    ds_read_b64_tr_b16 v[120:121], v221 offset:16384
    ds_read_b64_tr_b16 v[122:123], v221 offset:16896
    ds_read_b64_tr_b16 v[124:125], v221 offset:24576
    ds_read_b64_tr_b16 v[126:127], v221 offset:25088
    buffer_load_dwordx4 v234, s[16:19], s48 offen offset:1024 lds
    s_waitcnt vmcnt(22)
    ds_read_b64_tr_b16 a[8:9], v239 offset:2048
    ds_read_b64_tr_b16 a[12:13], v240 offset:2048
    ds_read_b64_tr_b16 a[10:11], v239 offset:3072
    ds_read_b64_tr_b16 a[14:15], v240 offset:3072
    v_mfma_f32_32x32x16_bf16 v[64:79], v[144:147], a[188:191], v[64:79]
    ds_read_b64_tr_b16 v[128:129], v221 offset:2048
    ds_read_b64_tr_b16 v[130:131], v221 offset:2560
    ds_read_b64_tr_b16 v[132:133], v221 offset:10240
    ds_read_b64_tr_b16 v[134:135], v221 offset:10752
    v_mfma_f32_32x32x16_bf16 v[80:95], v[148:151], a[188:191], v[80:95]
    ds_read_b64_tr_b16 v[136:137], v221 offset:18432
    ds_read_b64_tr_b16 v[138:139], v221 offset:18944
    ds_read_b64_tr_b16 v[140:141], v221 offset:26624
    ds_read_b64_tr_b16 v[142:143], v221 offset:27136
    s_waitcnt lgkmcnt(12)
    v_mfma_f32_32x32x16_bf16 v[64:79], v[112:115], a[192:195], v[64:79]
    s_waitcnt lgkmcnt(0)
    s_barrier
    ds_read_b64_tr_b16 v[144:145], v221 offset:32768
    ds_read_b64_tr_b16 v[146:147], v221 offset:33280
    s_add_u32 m0, s46, 104448
    s_lshl4_add_u32 s48, s66, 49152
    buffer_load_dwordx4 v233, s[16:19], s48 offen lds
    v_mfma_f32_32x32x16_bf16 v[64:79], v[116:119], a[196:199], v[64:79]
    ds_read_b64_tr_b16 v[148:149], v221 offset:40960
    ds_read_b64_tr_b16 v[150:151], v221 offset:41472
    buffer_load_dwordx4 v234, s[16:19], s48 offen offset:1024 lds
    v_mfma_f32_32x32x16_bf16 v[64:79], v[120:123], a[200:203], v[64:79]
    ds_read_b64_tr_b16 v[152:153], v221 offset:49152
    ds_read_b64_tr_b16 v[154:155], v221 offset:49664
    v_mfma_f32_32x32x16_bf16 v[64:79], v[124:127], a[204:207], v[64:79]
    ds_read_b64_tr_b16 v[156:157], v221 offset:57344
    ds_read_b64_tr_b16 v[158:159], v221 offset:57856
    v_mfma_f32_32x32x16_bf16 v[64:79], v[128:131], a[208:211], v[64:79]
    ds_read_b64_tr_b16 v[112:113], v221 offset:34816
    ds_read_b64_tr_b16 v[114:115], v221 offset:35328
    v_mfma_f32_32x32x16_bf16 v[64:79], v[132:135], a[212:215], v[64:79]
    ds_read_b64_tr_b16 v[116:117], v221 offset:43008
    ds_read_b64_tr_b16 v[118:119], v221 offset:43520
    s_add_u32 m0, s46, 0
    s_lshl4_add_u32 s48, s67, 0
    buffer_load_dwordx4 v233, s[16:19], s48 offen lds
    s_waitcnt vmcnt(23)
    ds_read_b64_tr_b16 a[16:17], v239 offset:4096
    ds_read_b64_tr_b16 a[20:21], v240 offset:4096
    ds_read_b64_tr_b16 a[18:19], v239 offset:5120
    ds_read_b64_tr_b16 a[22:23], v240 offset:5120
    v_mfma_f32_32x32x16_bf16 v[64:79], v[136:139], a[216:219], v[64:79]
    ds_read_b64_tr_b16 v[120:121], v221 offset:51200
    ds_read_b64_tr_b16 v[122:123], v221 offset:51712
    buffer_load_dwordx4 v234, s[16:19], s48 offen offset:1024 lds
    v_mfma_f32_32x32x16_bf16 v[64:79], v[140:143], a[220:223], v[64:79]
    ds_read_b64_tr_b16 v[124:125], v221 offset:59392
    ds_read_b64_tr_b16 v[126:127], v221 offset:59904
    s_waitcnt lgkmcnt(12)
    v_mfma_f32_32x32x16_bf16 v[64:79], v[144:147], a[224:227], v[64:79]
    ds_read_b64_tr_b16 v[128:129], v222 offset:0
    ds_read_b64_tr_b16 v[130:131], v222 offset:512
    v_mfma_f32_32x32x16_bf16 v[64:79], v[148:151], a[228:231], v[64:79]
    ds_read_b64_tr_b16 v[132:133], v222 offset:8192
    ds_read_b64_tr_b16 v[134:135], v222 offset:8704
    v_mfma_f32_32x32x16_bf16 v[64:79], v[152:155], a[232:235], v[64:79]
    ds_read_b64_tr_b16 v[136:137], v222 offset:16384
    ds_read_b64_tr_b16 v[138:139], v222 offset:16896
    s_add_u32 m0, s46, 2048
    s_lshl4_add_u32 s48, s67, 16384
    buffer_load_dwordx4 v233, s[16:19], s48 offen lds
    s_waitcnt vmcnt(23)
    ds_read_b64_tr_b16 a[24:25], v239 offset:6144
    ds_read_b64_tr_b16 a[28:29], v240 offset:6144
    ds_read_b64_tr_b16 a[26:27], v239 offset:7168
    ds_read_b64_tr_b16 a[30:31], v240 offset:7168
    v_mfma_f32_32x32x16_bf16 v[64:79], v[156:159], a[236:239], v[64:79]
    ds_read_b64_tr_b16 v[140:141], v222 offset:24576
    ds_read_b64_tr_b16 v[142:143], v222 offset:25088
    buffer_load_dwordx4 v234, s[16:19], s48 offen offset:1024 lds
    s_waitcnt lgkmcnt(12)
    v_mfma_f32_32x32x16_bf16 v[64:79], v[112:115], a[240:243], v[64:79]
    ds_read_b64_tr_b16 v[144:145], v222 offset:2048
    ds_read_b64_tr_b16 v[146:147], v222 offset:2560
    v_mfma_f32_32x32x16_bf16 v[64:79], v[116:119], a[244:247], v[64:79]
    ds_read_b64_tr_b16 v[148:149], v222 offset:10240
    ds_read_b64_tr_b16 v[150:151], v222 offset:10752
    v_mfma_f32_32x32x16_bf16 v[64:79], v[120:123], a[248:251], v[64:79]
    ds_read_b64_tr_b16 v[152:153], v222 offset:18432
    ds_read_b64_tr_b16 v[154:155], v222 offset:18944
    v_mfma_f32_32x32x16_bf16 v[64:79], v[124:127], a[252:255], v[64:79]
    ds_read_b64_tr_b16 v[156:157], v222 offset:26624
    ds_read_b64_tr_b16 v[158:159], v222 offset:27136
    s_add_u32 m0, s46, 32768
    s_lshl4_add_u32 s48, s67, 32768
    buffer_load_dwordx4 v233, s[16:19], s48 offen lds
    s_waitcnt lgkmcnt(8)
    v_mfma_f32_32x32x16_bf16 v[80:95], v[128:131], a[192:195], v[80:95]
    ds_read_b64_tr_b16 v[112:113], v222 offset:32768
    ds_read_b64_tr_b16 v[114:115], v222 offset:33280
    buffer_load_dwordx4 v234, s[16:19], s48 offen offset:1024 lds
    v_mfma_f32_32x32x16_bf16 v[80:95], v[132:135], a[196:199], v[80:95]
    ds_read_b64_tr_b16 v[116:117], v222 offset:40960
    ds_read_b64_tr_b16 v[118:119], v222 offset:41472
    s_waitcnt vmcnt(24)
    ds_read_b64_tr_b16 a[32:33], v235 offset:4096
    ds_read_b64_tr_b16 a[36:37], v236 offset:4096
    ds_read_b64_tr_b16 a[34:35], v235 offset:5120
    ds_read_b64_tr_b16 a[38:39], v236 offset:5120
    v_mul_f32 v192, s54, v64
    v_mul_f32 v193, s54, v65
    v_mul_f32 v194, s54, v66
    v_mul_f32 v195, s54, v67
    v_mul_f32 v196, s54, v68
    v_mul_f32 v197, s54, v69
    v_mul_f32 v198, s54, v70
    v_mul_f32 v199, s54, v71
    v_exp_f32_e64 v192, v192 clamp
    v_exp_f32_e64 v193, v193 clamp
    v_exp_f32_e64 v194, v194 clamp
    v_exp_f32_e64 v195, v195 clamp
    v_exp_f32_e64 v196, v196 clamp
    s_add_u32 m0, s46, 34816
    s_lshl4_add_u32 s48, s67, 49152
    buffer_load_dwordx4 v233, s[16:19], s48 offen lds
    v_exp_f32_e64 v197, v197 clamp
    v_mfma_f32_32x32x16_bf16 v[80:95], v[136:139], a[200:203], v[80:95]
    ds_read_b64_tr_b16 v[120:121], v222 offset:49152
    ds_read_b64_tr_b16 v[122:123], v222 offset:49664
    buffer_load_dwordx4 v234, s[16:19], s48 offen offset:1024 lds
    v_exp_f32_e64 v198, v198 clamp
    v_exp_f32_e64 v199, v199 clamp
    v_max_f32 v64, 0x358637bd, v64
    v_max_f32 v65, 0x358637bd, v65
    v_max_f32 v66, 0x358637bd, v66
    v_max_f32 v67, 0x358637bd, v67
    v_max_f32 v68, 0x358637bd, v68
    v_max_f32 v69, 0x358637bd, v69
    v_max_f32 v70, 0x358637bd, v70
    v_max_f32 v71, 0x358637bd, v71
    v_add_f32 v64, v64, v192
    v_add_f32 v65, v65, v193
    v_add_f32 v66, v66, v194
    v_add_f32 v67, v67, v195
    v_add_f32 v68, v68, v196
    v_add_f32 v69, v69, v197
    v_add_f32 v70, v70, v198
    v_add_f32 v71, v71, v199
    v_mfma_f32_32x32x16_bf16 v[80:95], v[140:143], a[204:207], v[80:95]
    ds_read_b64_tr_b16 v[124:125], v222 offset:57344
    ds_read_b64_tr_b16 v[126:127], v222 offset:57856
    v_cvt_pk_bf16_f32 v64, v64, v65
    v_cvt_pk_bf16_f32 v65, v66, v67
    v_cvt_pk_bf16_f32 v66, v68, v69
    v_cvt_pk_bf16_f32 v67, v70, v71
    s_add_u32 m0, s46, 131072
    s_lshl4_add_u32 s48, s68, 0
    buffer_load_dwordx4 v233, s[16:19], s48 offen lds
    buffer_store_dwordx4 v[64:67], v244, s[24:27], 0 offen offset:0 sc1
    v_mul_f32 v200, s54, v72
    v_mul_f32 v201, s54, v73
    v_mul_f32 v202, s54, v74
    v_mul_f32 v203, s54, v75
    v_mul_f32 v204, s54, v76
    v_mul_f32 v205, s54, v77
    v_mul_f32 v206, s54, v78
    s_waitcnt vmcnt(26)
    ds_read_b64_tr_b16 a[40:41], v235 offset:6144
    ds_read_b64_tr_b16 a[44:45], v236 offset:6144
    ds_read_b64_tr_b16 a[42:43], v235 offset:7168
    ds_read_b64_tr_b16 a[46:47], v236 offset:7168
    v_mul_f32 v207, s54, v79
    v_exp_f32_e64 v200, v200 clamp
    v_exp_f32_e64 v201, v201 clamp
    v_exp_f32_e64 v202, v202 clamp
    v_exp_f32_e64 v203, v203 clamp
    s_waitcnt lgkmcnt(15)
    v_mfma_f32_32x32x16_bf16 v[80:95], v[144:147], a[208:211], v[80:95]
    ds_read_b64_tr_b16 v[128:129], v222 offset:34816
    ds_read_b64_tr_b16 v[130:131], v222 offset:35328
    buffer_load_dwordx4 v234, s[16:19], s48 offen offset:1024 lds
    v_exp_f32_e64 v204, v204 clamp
    v_exp_f32_e64 v205, v205 clamp
    v_exp_f32_e64 v206, v206 clamp
    v_exp_f32_e64 v207, v207 clamp
    v_max_f32 v72, 0x358637bd, v72
    v_max_f32 v73, 0x358637bd, v73
    v_max_f32 v74, 0x358637bd, v74
    v_max_f32 v75, 0x358637bd, v75
    v_max_f32 v76, 0x358637bd, v76
    v_max_f32 v77, 0x358637bd, v77
    buffer_load_dwordx4 v[160:163], v212, s[24:27], s93 offen offset:0 sc1
    buffer_load_dwordx4 v[164:167], v212, s[24:27], s93 offen offset:1024 sc1
    buffer_load_dwordx4 v[168:171], v212, s[24:27], s92 offen offset:0 sc1
    buffer_load_dwordx4 v[172:175], v212, s[24:27], s92 offen offset:1024 sc1
    s_waitcnt vmcnt(29)
    ds_read_b64_tr_b16 a[48:49], v235 offset:36864
    ds_read_b64_tr_b16 a[52:53], v236 offset:36864
    ds_read_b64_tr_b16 a[50:51], v235 offset:37888
    ds_read_b64_tr_b16 a[54:55], v236 offset:37888
    v_max_f32 v78, 0x358637bd, v78
    v_max_f32 v79, 0x358637bd, v79
    v_add_f32 v72, v72, v200
    v_add_f32 v73, v73, v201
    v_add_f32 v74, v74, v202
    v_add_f32 v75, v75, v203
    v_mfma_f32_32x32x16_bf16 v[80:95], v[148:151], a[212:215], v[80:95]
    ds_read_b64_tr_b16 v[132:133], v222 offset:43008
    ds_read_b64_tr_b16 v[134:135], v222 offset:43520
    s_waitcnt vmcnt(27)
    ds_read_b64_tr_b16 a[56:57], v235 offset:38912
    ds_read_b64_tr_b16 a[60:61], v236 offset:38912
    ds_read_b64_tr_b16 a[58:59], v235 offset:39936
    ds_read_b64_tr_b16 a[62:63], v236 offset:39936
    v_add_f32 v76, v76, v204
    v_add_f32 v77, v77, v205
    v_add_f32 v78, v78, v206
    v_add_f32 v79, v79, v207
    s_add_u32 m0, s46, 133120
    s_lshl4_add_u32 s48, s68, 16384
    buffer_load_dwordx4 v233, s[16:19], s48 offen lds
    v_cvt_pk_bf16_f32 v72, v72, v73
    v_cvt_pk_bf16_f32 v73, v74, v75
    v_cvt_pk_bf16_f32 v74, v76, v77
    v_cvt_pk_bf16_f32 v75, v78, v79
    buffer_store_dwordx4 v[72:75], v244, s[24:27], 0 offen offset:1024 sc1
    v_mfma_f32_32x32x16_bf16 v[80:95], v[152:155], a[216:219], v[80:95]
    ds_read_b64_tr_b16 v[136:137], v222 offset:51200
    ds_read_b64_tr_b16 v[138:139], v222 offset:51712
    s_waitcnt vmcnt(27)
    ds_read_b64_tr_b16 a[64:65], v237 offset:4096
    ds_read_b64_tr_b16 a[68:69], v238 offset:4096
    ds_read_b64_tr_b16 a[66:67], v237 offset:5120
    ds_read_b64_tr_b16 a[70:71], v238 offset:5120
    v_mfma_f32_32x32x16_bf16 v[80:95], v[156:159], a[220:223], v[80:95]
    ds_read_b64_tr_b16 v[140:141], v222 offset:59392
    ds_read_b64_tr_b16 v[142:143], v222 offset:59904
    s_waitcnt lgkmcnt(15)
    v_mfma_f32_32x32x16_bf16 v[80:95], v[112:115], a[224:227], v[80:95]
    s_waitcnt lgkmcnt(0)
    s_barrier
    buffer_load_dwordx4 v234, s[16:19], s48 offen offset:1024 lds
    v_mfma_f32_32x32x16_bf16 v[80:95], v[116:119], a[228:231], v[80:95]
    v_mfma_f32_32x32x16_bf16 v[80:95], v[120:123], a[232:235], v[80:95]
    s_add_u32 m0, s46, 65536
    s_lshl4_add_u32 s48, s68, 32768
    buffer_load_dwordx4 v233, s[16:19], s48 offen lds
    v_mfma_f32_32x32x16_bf16 v[80:95], v[124:127], a[236:239], v[80:95]
    v_mfma_f32_32x32x16_bf16 v[80:95], v[128:131], a[240:243], v[80:95]
    buffer_load_dwordx4 v234, s[16:19], s48 offen offset:1024 lds
    v_mfma_f32_32x32x16_bf16 v[80:95], v[132:135], a[244:247], v[80:95]
    v_mfma_f32_32x32x16_bf16 v[80:95], v[136:139], a[248:251], v[80:95]
    v_mfma_f32_32x32x16_bf16 v[80:95], v[140:143], a[252:255], v[80:95]
    s_add_u32 m0, s46, 67584
    s_lshl4_add_u32 s48, s69, 0
    buffer_load_dwordx4 v233, s[16:19], s48 offen lds
    s_waitcnt vmcnt(25)
    ds_read_b64_tr_b16 a[72:73], v237 offset:6144
    ds_read_b64_tr_b16 a[76:77], v238 offset:6144
    ds_read_b64_tr_b16 a[74:75], v237 offset:7168
    ds_read_b64_tr_b16 a[78:79], v238 offset:7168
    s_waitcnt vmcnt(23)
    ds_read_b64_tr_b16 a[80:81], v237 offset:36864
    ds_read_b64_tr_b16 a[84:85], v238 offset:36864
    ds_read_b64_tr_b16 a[82:83], v237 offset:37888
    ds_read_b64_tr_b16 a[86:87], v238 offset:37888
    buffer_load_dwordx4 v234, s[16:19], s48 offen offset:1024 lds
    s_waitcnt vmcnt(22)
    ds_read_b64_tr_b16 a[88:89], v237 offset:38912
    ds_read_b64_tr_b16 a[92:93], v238 offset:38912
    ds_read_b64_tr_b16 a[90:91], v237 offset:39936
    ds_read_b64_tr_b16 a[94:95], v238 offset:39936
    s_waitcnt vmcnt(20)
    ds_read_b64_tr_b16 a[96:97], v235 offset:0
    ds_read_b64_tr_b16 a[100:101], v236 offset:0
    ds_read_b64_tr_b16 a[98:99], v235 offset:1024
    ds_read_b64_tr_b16 a[102:103], v236 offset:1024
    s_waitcnt vmcnt(18)
    ds_read_b64_tr_b16 a[104:105], v235 offset:2048
    ds_read_b64_tr_b16 a[108:109], v236 offset:2048
    ds_read_b64_tr_b16 a[106:107], v235 offset:3072
    ds_read_b64_tr_b16 a[110:111], v236 offset:3072
    s_waitcnt vmcnt(16)
    ds_read_b64_tr_b16 a[112:113], v235 offset:32768
    ds_read_b64_tr_b16 a[116:117], v236 offset:32768
    ds_read_b64_tr_b16 a[114:115], v235 offset:33792
    ds_read_b64_tr_b16 a[118:119], v236 offset:33792
    s_add_u32 m0, s46, 98304
    s_lshl4_add_u32 s48, s69, 16384
    buffer_load_dwordx4 v233, s[16:19], s48 offen lds
    v_mul_f32 v192, s54, v80
    v_mul_f32 v193, s54, v81
    s_waitcnt vmcnt(15)
    ds_read_b64_tr_b16 a[120:121], v235 offset:34816
    ds_read_b64_tr_b16 a[124:125], v236 offset:34816
    ds_read_b64_tr_b16 a[122:123], v235 offset:35840
    ds_read_b64_tr_b16 a[126:127], v236 offset:35840
    v_mul_f32 v194, s54, v82
    v_mul_f32 v195, s54, v83
    v_mul_f32 v196, s54, v84
    v_mul_f32 v197, s54, v85
    v_mul_f32 v198, s54, v86
    v_mul_f32 v199, s54, v87
    v_exp_f32_e64 v192, v192 clamp
    buffer_load_dwordx4 v234, s[16:19], s48 offen offset:1024 lds
    v_exp_f32_e64 v193, v193 clamp
    v_exp_f32_e64 v194, v194 clamp
    v_exp_f32_e64 v195, v195 clamp
    v_exp_f32_e64 v196, v196 clamp
    v_exp_f32_e64 v197, v197 clamp
    v_exp_f32_e64 v198, v198 clamp
    v_exp_f32_e64 v199, v199 clamp
    v_max_f32 v80, 0x358637bd, v80
    v_max_f32 v81, 0x358637bd, v81
    s_add_u32 m0, s46, 100352
    s_lshl4_add_u32 s48, s69, 32768
    buffer_load_dwordx4 v233, s[16:19], s48 offen lds
    v_max_f32 v82, 0x358637bd, v82
    v_max_f32 v83, 0x358637bd, v83
    v_max_f32 v84, 0x358637bd, v84
    v_max_f32 v85, 0x358637bd, v85
    v_max_f32 v86, 0x358637bd, v86
    v_max_f32 v87, 0x358637bd, v87
    v_add_f32 v80, v80, v192
    v_add_f32 v81, v81, v193
    v_add_f32 v82, v82, v194
    v_add_f32 v83, v83, v195
    v_add_f32 v84, v84, v196
    v_add_f32 v85, v85, v197
    v_add_f32 v86, v86, v198
    v_add_f32 v87, v87, v199
    v_cvt_pk_bf16_f32 v80, v80, v81
    buffer_load_dwordx4 v234, s[16:19], s48 offen offset:1024 lds
    v_cvt_pk_bf16_f32 v81, v82, v83
    v_cvt_pk_bf16_f32 v82, v84, v85
    v_cvt_pk_bf16_f32 v83, v86, v87
    buffer_store_dwordx4 v[80:83], v244, s[24:27], 0 offen offset:2048 sc1
    v_mul_f32 v200, s54, v88
    v_mul_f32 v201, s54, v89
    v_mul_f32 v202, s54, v90
    v_mul_f32 v203, s54, v91
    v_mul_f32 v204, s54, v92
    v_mul_f32 v205, s54, v93
    v_mul_f32 v206, s54, v94
    v_mul_f32 v207, s54, v95
    v_exp_f32_e64 v200, v200 clamp
    v_exp_f32_e64 v201, v201 clamp
    v_exp_f32_e64 v202, v202 clamp
    v_exp_f32_e64 v203, v203 clamp
    v_exp_f32_e64 v204, v204 clamp
    v_exp_f32_e64 v205, v205 clamp
    v_exp_f32_e64 v206, v206 clamp
    s_add_u32 m0, s46, 135168
    s_lshl4_add_u32 s48, s70, 0
    buffer_load_dwordx4 v233, s[16:19], s48 offen lds
    v_exp_f32_e64 v207, v207 clamp
    s_waitcnt vmcnt(17)
    ds_read_b64_tr_b16 a[128:129], v239 offset:0
    ds_read_b64_tr_b16 a[132:133], v240 offset:0
    ds_read_b64_tr_b16 a[130:131], v239 offset:1024
    ds_read_b64_tr_b16 a[134:135], v240 offset:1024
    v_max_f32 v88, 0x358637bd, v88
    v_max_f32 v89, 0x358637bd, v89
    v_max_f32 v90, 0x358637bd, v90
    v_max_f32 v91, 0x358637bd, v91
    v_max_f32 v92, 0x358637bd, v92
    v_max_f32 v93, 0x358637bd, v93
    v_max_f32 v94, 0x358637bd, v94
    v_max_f32 v95, 0x358637bd, v95
    v_add_f32 v88, v88, v200
    buffer_load_dwordx4 v234, s[16:19], s48 offen offset:1024 lds
    v_add_f32 v89, v89, v201
    v_add_f32 v90, v90, v202
    v_add_f32 v91, v91, v203
    v_add_f32 v92, v92, v204
    v_add_f32 v93, v93, v205
    v_add_f32 v94, v94, v206
    v_add_f32 v95, v95, v207
    v_cvt_pk_bf16_f32 v88, v88, v89
    v_cvt_pk_bf16_f32 v89, v90, v91
    v_cvt_pk_bf16_f32 v90, v92, v93
    v_cvt_pk_bf16_f32 v91, v94, v95
    buffer_store_dwordx4 v[88:91], v244, s[24:27], 0 offen offset:3072 sc1
    s_add_u32 m0, s46, 137216
    s_lshl4_add_u32 s48, s70, 16384
    buffer_load_dwordx4 v233, s[16:19], s48 offen lds
    s_waitcnt vmcnt(16)
    v_min3_u32 v176, v161, v163, v165
    v_min3_u32 v176, v176, v167, v169
    v_min3_u32 v176, v176, v171, v173
    v_min_u32 v176, v176, v175
    v_max3_u32 v177, v161, v163, v165
    v_max3_u32 v177, v177, v167, v169
    v_max3_u32 v177, v177, v171, v173
    v_max_u32 v177, v177, v175
    v_cmp_ne_u32 vcc, s47, v176
    v_cmp_ne_u32 s[60:61], s47, v177
    s_nop 4
    s_or_b64 s[60:61], vcc, s[60:61]
    s_cbranch_scc1 L_spin20
L_ok19:
    v_add_f32 v160, v160, v168
    v_add_f32 v162, v162, v170
    v_add_f32 v164, v164, v172
    v_add_f32 v166, v166, v174
    v_add_f32_dpp v160, v160, v160 row_ror:8 row_mask:0xf bank_mask:0xf
    v_add_f32_dpp v162, v162, v162 row_ror:8 row_mask:0xf bank_mask:0xf
    v_add_f32_dpp v164, v164, v164 row_ror:8 row_mask:0xf bank_mask:0xf
    v_add_f32_dpp v166, v166, v166 row_ror:8 row_mask:0xf bank_mask:0xf
    v_mov_b32 v161, v160
    v_mov_b32 v163, v162
    v_mov_b32 v165, v164
    v_mov_b32 v167, v166
    v_permlane16_swap_b32 v160, v161
    v_permlane16_swap_b32 v162, v163
    v_permlane16_swap_b32 v164, v165
    v_permlane16_swap_b32 v166, v167
    v_add_f32 v160, v160, v161
    v_add_f32 v162, v162, v163
    v_add_f32 v164, v164, v165
    v_add_f32 v166, v166, v167
    v_mov_b32 v161, v160
    v_mov_b32 v163, v162
    v_mov_b32 v165, v164
    v_mov_b32 v167, v166
    v_permlane32_swap_b32 v160, v161
    v_permlane32_swap_b32 v162, v163
    v_permlane32_swap_b32 v164, v165
    v_permlane32_swap_b32 v166, v167
    v_add_f32 v160, v160, v161
    v_add_f32 v162, v162, v163
    v_add_f32 v164, v164, v165
    v_add_f32 v166, v166, v167
    v_cvt_pk_bf16_f32 v160, v160, v162
    v_cvt_pk_bf16_f32 v161, v164, v166
    buffer_store_dwordx2 v[160:161], v213, s[24:27], s94 offen sc1
    buffer_load_dword v243, v231, s[24:27], s89 offen sc1
    buffer_load_dwordx4 v234, s[16:19], s48 offen offset:1024 lds
    s_add_u32 m0, s46, 4096
    s_lshl4_add_u32 s48, s70, 32768
    buffer_load_dwordx4 v233, s[16:19], s48 offen lds
    buffer_load_dwordx4 v234, s[16:19], s48 offen offset:1024 lds
    s_waitcnt vmcnt(18)
    ds_read_b64_tr_b16 a[136:137], v239 offset:2048
    ds_read_b64_tr_b16 a[140:141], v240 offset:2048
    ds_read_b64_tr_b16 a[138:139], v239 offset:3072
    ds_read_b64_tr_b16 a[142:143], v240 offset:3072
    s_add_u32 m0, s46, 6144
    s_lshl4_add_u32 s48, s71, 0
    buffer_load_dwordx4 v233, s[16:19], s48 offen lds
    s_waitcnt vmcnt(17)
    ds_read_b64_tr_b16 a[144:145], v237 offset:0
    ds_read_b64_tr_b16 a[148:149], v238 offset:0
    ds_read_b64_tr_b16 a[146:147], v237 offset:1024
    ds_read_b64_tr_b16 a[150:151], v238 offset:1024
    buffer_load_dwordx4 v234, s[16:19], s48 offen offset:1024 lds
    s_add_u32 m0, s46, 36864
    s_lshl4_add_u32 s48, s71, 16384
    buffer_load_dwordx4 v233, s[16:19], s48 offen lds
    s_waitcnt vmcnt(17)
    ds_read_b64_tr_b16 a[152:153], v237 offset:2048
    ds_read_b64_tr_b16 a[156:157], v238 offset:2048
    ds_read_b64_tr_b16 a[154:155], v237 offset:3072
    ds_read_b64_tr_b16 a[158:159], v238 offset:3072
    buffer_load_dwordx4 v234, s[16:19], s48 offen offset:1024 lds
    s_add_u32 m0, s46, 38912
    s_lshl4_add_u32 s48, s71, 32768
    buffer_load_dwordx4 v233, s[16:19], s48 offen lds
    s_waitcnt vmcnt(17)
    ds_read_b64_tr_b16 a[160:161], v237 offset:32768
    ds_read_b64_tr_b16 a[164:165], v238 offset:32768
    ds_read_b64_tr_b16 a[162:163], v237 offset:33792
    ds_read_b64_tr_b16 a[166:167], v238 offset:33792
    buffer_load_dwordx4 v234, s[16:19], s48 offen offset:1024 lds
    s_add_u32 m0, s46, 69632
    s_lshl4_add_u32 s48, s72, 0
    buffer_load_dwordx4 v233, s[20:23], s48 offen lds
    s_waitcnt vmcnt(17)
    ds_read_b64_tr_b16 a[168:169], v237 offset:34816
    ds_read_b64_tr_b16 a[172:173], v238 offset:34816
    ds_read_b64_tr_b16 a[170:171], v237 offset:35840
    ds_read_b64_tr_b16 a[174:175], v238 offset:35840
    buffer_load_dwordx4 v234, s[20:23], s48 offen offset:1024 lds
    s_waitcnt lgkmcnt(15)
    s_add_u32 m0, s46, 71680
    s_lshl4_add_u32 s48, s72, 16384
    buffer_load_dwordx4 v233, s[20:23], s48 offen lds
    buffer_load_dwordx4 v234, s[20:23], s48 offen offset:1024 lds
    s_add_u32 m0, s46, 102400
    s_lshl4_add_u32 s48, s73, 0
    buffer_load_dwordx4 v233, s[20:23], s48 offen lds
    s_waitcnt vmcnt(18)
    ds_read_b64_tr_b16 a[176:177], v239 offset:4096
    ds_read_b64_tr_b16 a[180:181], v240 offset:4096
    ds_read_b64_tr_b16 a[178:179], v239 offset:5120
    ds_read_b64_tr_b16 a[182:183], v240 offset:5120
    buffer_load_dwordx4 v234, s[20:23], s48 offen offset:1024 lds
    s_add_u32 m0, s46, 104448
    s_lshl4_add_u32 s48, s73, 16384
    buffer_load_dwordx4 v233, s[20:23], s48 offen lds
    buffer_load_dwordx4 v234, s[20:23], s48 offen offset:1024 lds
    s_waitcnt vmcnt(20)
    buffer_store_dword v230, v245, s[24:27], 0 offen sc1
    s_add_u32 m0, s46, 0
    s_lshl4_add_u32 s48, s74, 0
    buffer_load_dwordx4 v233, s[20:23], s48 offen lds
    s_waitcnt vmcnt(20)
    buffer_store_dword v230, v214, s[24:27], s95 offen sc1
    s_waitcnt vmcnt(20)
    v_cmp_ne_u32 vcc, s47, v243
    s_nop 4
    s_and_b64 s[60:61], vcc, s[76:77]
    s_cbranch_scc1 L_spin23
L_ok22:
    s_waitcnt vmcnt(19)
    ds_read_b64_tr_b16 a[184:185], v239 offset:6144
    ds_read_b64_tr_b16 a[188:189], v240 offset:6144
    ds_read_b64_tr_b16 a[186:187], v239 offset:7168
    ds_read_b64_tr_b16 a[190:191], v240 offset:7168
    s_waitcnt vmcnt(17)
    ds_read_b64_tr_b16 a[192:193], v235 offset:4096
    ds_read_b64_tr_b16 a[196:197], v236 offset:4096
    ds_read_b64_tr_b16 a[194:195], v235 offset:5120
    ds_read_b64_tr_b16 a[198:199], v236 offset:5120
    buffer_load_dwordx4 v[96:99], v225, s[24:27], s64 offen offset:0 sc1
    buffer_load_dwordx4 v[100:103], v226, s[24:27], s64 offen offset:0 sc1
    buffer_load_dwordx4 v[104:107], v225, s[24:27], s64 offen offset:1024 sc1
    s_waitcnt vmcnt(18)
    ds_read_b64_tr_b16 a[200:201], v235 offset:6144
    ds_read_b64_tr_b16 a[204:205], v236 offset:6144
    ds_read_b64_tr_b16 a[202:203], v235 offset:7168
    ds_read_b64_tr_b16 a[206:207], v236 offset:7168
    buffer_load_dwordx4 v[108:111], v226, s[24:27], s64 offen offset:1024 sc1
    buffer_load_dwordx4 v[112:115], v225, s[24:27], s64 offen offset:2048 sc1
    s_waitcnt vmcnt(18)
    ds_read_b64_tr_b16 a[208:209], v235 offset:36864
    ds_read_b64_tr_b16 a[212:213], v236 offset:36864
    ds_read_b64_tr_b16 a[210:211], v235 offset:37888
    ds_read_b64_tr_b16 a[214:215], v236 offset:37888
    buffer_load_dwordx4 v[116:119], v226, s[24:27], s64 offen offset:2048 sc1
    buffer_load_dwordx4 v[120:123], v225, s[24:27], s64 offen offset:3072 sc1
    s_waitcnt vmcnt(18)
    ds_read_b64_tr_b16 a[216:217], v235 offset:38912
    ds_read_b64_tr_b16 a[220:221], v236 offset:38912
    ds_read_b64_tr_b16 a[218:219], v235 offset:39936
    ds_read_b64_tr_b16 a[222:223], v236 offset:39936
    buffer_load_dwordx4 v[124:127], v226, s[24:27], s64 offen offset:3072 sc1
    buffer_load_dwordx4 v[128:131], v225, s[24:27], s65 offen offset:0 sc1
    buffer_load_dwordx4 v[132:135], v226, s[24:27], s65 offen offset:0 sc1
    buffer_load_dwordx4 v[136:139], v225, s[24:27], s65 offen offset:1024 sc1
    buffer_load_dwordx4 v[140:143], v226, s[24:27], s65 offen offset:1024 sc1
    buffer_load_dwordx4 v[144:147], v225, s[24:27], s65 offen offset:2048 sc1
    buffer_load_dwordx4 v[148:151], v226, s[24:27], s65 offen offset:2048 sc1
    buffer_load_dwordx4 v[152:155], v225, s[24:27], s65 offen offset:3072 sc1
    buffer_load_dwordx4 v[156:159], v226, s[24:27], s65 offen offset:3072 sc1
    buffer_load_dwordx4 v[64:67], v225, s[24:27], s66 offen offset:0 sc1
    buffer_load_dwordx4 v[68:71], v226, s[24:27], s66 offen offset:0 sc1
    s_waitcnt vmcnt(16)
    v_mfma_f32_32x32x16_bf16 v[0:15], a[0:3], v[96:99], 0
    v_mfma_f32_32x32x16_bf16 v[16:31], a[4:7], v[96:99], 0
    buffer_load_dwordx4 v[72:75], v225, s[24:27], s66 offen offset:1024 sc1
    v_mfma_f32_32x32x16_bf16 v[32:47], a[0:3], v[100:103], 0
    v_mfma_f32_32x32x16_bf16 v[48:63], a[4:7], v[100:103], 0
    s_waitcnt vmcnt(15)
    v_mfma_f32_32x32x16_bf16 v[0:15], a[8:11], v[104:107], v[0:15]
    buffer_load_dwordx4 v[76:79], v226, s[24:27], s66 offen offset:1024 sc1
    v_mfma_f32_32x32x16_bf16 v[16:31], a[12:15], v[104:107], v[16:31]
    v_mfma_f32_32x32x16_bf16 v[32:47], a[8:11], v[108:111], v[32:47]
    buffer_load_dwordx4 v[80:83], v225, s[24:27], s66 offen offset:2048 sc1
    v_mfma_f32_32x32x16_bf16 v[48:63], a[12:15], v[108:111], v[48:63]
    ds_read_b64_tr_b16 a[0:1], v237 offset:4096
    ds_read_b64_tr_b16 a[4:5], v238 offset:4096
    ds_read_b64_tr_b16 a[2:3], v237 offset:5120
    ds_read_b64_tr_b16 a[6:7], v238 offset:5120
    s_waitcnt vmcnt(15)
    v_mfma_f32_32x32x16_bf16 v[0:15], a[16:19], v[112:115], v[0:15]
    buffer_load_dwordx4 v[84:87], v226, s[24:27], s66 offen offset:2048 sc1
    v_mfma_f32_32x32x16_bf16 v[16:31], a[20:23], v[112:115], v[16:31]
    v_mfma_f32_32x32x16_bf16 v[32:47], a[16:19], v[116:119], v[32:47]
    buffer_load_dwordx4 v[88:91], v225, s[24:27], s66 offen offset:3072 sc1
    v_mfma_f32_32x32x16_bf16 v[48:63], a[20:23], v[116:119], v[48:63]
    ds_read_b64_tr_b16 a[8:9], v237 offset:6144
    ds_read_b64_tr_b16 a[12:13], v238 offset:6144
    ds_read_b64_tr_b16 a[10:11], v237 offset:7168
    ds_read_b64_tr_b16 a[14:15], v238 offset:7168
    s_waitcnt vmcnt(15)
    v_mfma_f32_32x32x16_bf16 v[0:15], a[24:27], v[120:123], v[0:15]
    v_mfma_f32_32x32x16_bf16 v[16:31], a[28:31], v[120:123], v[16:31]
    buffer_load_dwordx4 v[92:95], v226, s[24:27], s66 offen offset:3072 sc1
    v_mfma_f32_32x32x16_bf16 v[32:47], a[24:27], v[124:127], v[32:47]
    v_mfma_f32_32x32x16_bf16 v[48:63], a[28:31], v[124:127], v[48:63]
    buffer_load_dwordx4 v[160:163], v225, s[24:27], s67 offen offset:0 sc1
    ds_read_b64_tr_b16 a[16:17], v237 offset:36864
    ds_read_b64_tr_b16 a[20:21], v238 offset:36864
    ds_read_b64_tr_b16 a[18:19], v237 offset:37888
    ds_read_b64_tr_b16 a[22:23], v238 offset:37888
    s_waitcnt vmcnt(15)
    v_mfma_f32_32x32x16_bf16 v[0:15], a[32:35], v[128:131], v[0:15]
    v_mfma_f32_32x32x16_bf16 v[16:31], a[36:39], v[128:131], v[16:31]
    buffer_load_dwordx4 v[164:167], v226, s[24:27], s67 offen offset:0 sc1
    v_mfma_f32_32x32x16_bf16 v[32:47], a[32:35], v[132:135], v[32:47]
    v_mfma_f32_32x32x16_bf16 v[48:63], a[36:39], v[132:135], v[48:63]
    buffer_load_dwordx4 v[168:171], v225, s[24:27], s67 offen offset:1024 sc1
    ds_read_b64_tr_b16 a[24:25], v237 offset:38912
    ds_read_b64_tr_b16 a[28:29], v238 offset:38912
    ds_read_b64_tr_b16 a[26:27], v237 offset:39936
    ds_read_b64_tr_b16 a[30:31], v238 offset:39936
    s_waitcnt vmcnt(15)
    v_mfma_f32_32x32x16_bf16 v[0:15], a[40:43], v[136:139], v[0:15]
    v_mfma_f32_32x32x16_bf16 v[16:31], a[44:47], v[136:139], v[16:31]
    buffer_load_dwordx4 v[172:175], v226, s[24:27], s67 offen offset:1024 sc1
    v_mfma_f32_32x32x16_bf16 v[32:47], a[40:43], v[140:143], v[32:47]
    v_mfma_f32_32x32x16_bf16 v[48:63], a[44:47], v[140:143], v[48:63]
    buffer_load_dwordx4 v[176:179], v225, s[24:27], s67 offen offset:2048 sc1
    s_waitcnt vmcnt(15)
    v_mfma_f32_32x32x16_bf16 v[0:15], a[48:51], v[144:147], v[0:15]
    v_mfma_f32_32x32x16_bf16 v[16:31], a[52:55], v[144:147], v[16:31]
    buffer_load_dwordx4 v[180:183], v226, s[24:27], s67 offen offset:2048 sc1
    v_mfma_f32_32x32x16_bf16 v[32:47], a[48:51], v[148:151], v[32:47]
    v_mfma_f32_32x32x16_bf16 v[48:63], a[52:55], v[148:151], v[48:63]
    buffer_load_dwordx4 v[184:187], v225, s[24:27], s67 offen offset:3072 sc1
    s_waitcnt vmcnt(15)
    v_mfma_f32_32x32x16_bf16 v[0:15], a[56:59], v[152:155], v[0:15]
    v_mfma_f32_32x32x16_bf16 v[16:31], a[60:63], v[152:155], v[16:31]
    buffer_load_dwordx4 v[188:191], v226, s[24:27], s67 offen offset:3072 sc1
    v_mfma_f32_32x32x16_bf16 v[32:47], a[56:59], v[156:159], v[32:47]
    v_mfma_f32_32x32x16_bf16 v[48:63], a[60:63], v[156:159], v[48:63]
    buffer_load_dwordx4 v234, s[20:23], s48 offen offset:1024 lds
    s_waitcnt vmcnt(15)
    v_mfma_f32_32x32x16_bf16 v[0:15], a[64:67], v[64:67], v[0:15]
    buffer_load_dword v243, v231, s[24:27], s89 offen sc1
    buffer_load_dwordx2 v[252:253], v232, s[24:27], s90 offen sc1
    v_mfma_f32_32x32x16_bf16 v[16:31], a[68:71], v[64:67], v[16:31]
    v_mfma_f32_32x32x16_bf16 v[32:47], a[64:67], v[68:71], v[32:47]
    v_mfma_f32_32x32x16_bf16 v[48:63], a[68:71], v[68:71], v[48:63]
    s_add_u32 m0, s46, 2048
    s_lshl4_add_u32 s48, s74, 16384
    buffer_load_dwordx4 v233, s[20:23], s48 offen lds
    s_waitcnt vmcnt(16)
    v_mfma_f32_32x32x16_bf16 v[0:15], a[72:75], v[72:75], v[0:15]
    v_mfma_f32_32x32x16_bf16 v[16:31], a[76:79], v[72:75], v[16:31]
    buffer_load_dwordx4 v234, s[20:23], s48 offen offset:1024 lds
    v_mfma_f32_32x32x16_bf16 v[32:47], a[72:75], v[76:79], v[32:47]
    v_mfma_f32_32x32x16_bf16 v[48:63], a[76:79], v[76:79], v[48:63]
    s_add_u32 m0, s46, 32768
    s_lshl4_add_u32 s48, s75, 0
    buffer_load_dwordx4 v233, s[20:23], s48 offen lds
    s_waitcnt vmcnt(16)
    v_mfma_f32_32x32x16_bf16 v[0:15], a[80:83], v[80:83], v[0:15]
    v_mfma_f32_32x32x16_bf16 v[16:31], a[84:87], v[80:83], v[16:31]
    buffer_load_dwordx4 v234, s[20:23], s48 offen offset:1024 lds
    v_mfma_f32_32x32x16_bf16 v[32:47], a[80:83], v[84:87], v[32:47]
    v_mfma_f32_32x32x16_bf16 v[48:63], a[84:87], v[84:87], v[48:63]
    s_add_u32 m0, s46, 34816
    s_lshl4_add_u32 s48, s75, 16384
    buffer_load_dwordx4 v233, s[20:23], s48 offen lds
    s_waitcnt vmcnt(16)
    v_mfma_f32_32x32x16_bf16 v[0:15], a[88:91], v[88:91], v[0:15]
    v_mfma_f32_32x32x16_bf16 v[16:31], a[92:95], v[88:91], v[16:31]
    buffer_load_dwordx4 v234, s[20:23], s48 offen offset:1024 lds
    v_mfma_f32_32x32x16_bf16 v[32:47], a[88:91], v[92:95], v[32:47]
    v_mfma_f32_32x32x16_bf16 v[48:63], a[92:95], v[92:95], v[48:63]
    s_waitcnt vmcnt(15)
    v_mfma_f32_32x32x16_bf16 v[0:15], a[96:99], v[160:163], v[0:15]
    v_mfma_f32_32x32x16_bf16 v[16:31], a[100:103], v[160:163], v[16:31]
    v_mfma_f32_32x32x16_bf16 v[32:47], a[96:99], v[164:167], v[32:47]
    v_mfma_f32_32x32x16_bf16 v[48:63], a[100:103], v[164:167], v[48:63]
    s_waitcnt vmcnt(13)
    v_mfma_f32_32x32x16_bf16 v[0:15], a[104:107], v[168:171], v[0:15]
    v_mfma_f32_32x32x16_bf16 v[16:31], a[108:111], v[168:171], v[16:31]
    v_mfma_f32_32x32x16_bf16 v[32:47], a[104:107], v[172:175], v[32:47]
    v_mfma_f32_32x32x16_bf16 v[48:63], a[108:111], v[172:175], v[48:63]
    s_waitcnt vmcnt(11)
    v_mfma_f32_32x32x16_bf16 v[0:15], a[112:115], v[176:179], v[0:15]
    v_mfma_f32_32x32x16_bf16 v[16:31], a[116:119], v[176:179], v[16:31]
    v_mfma_f32_32x32x16_bf16 v[32:47], a[112:115], v[180:183], v[32:47]
    v_mfma_f32_32x32x16_bf16 v[48:63], a[116:119], v[180:183], v[48:63]
    s_waitcnt vmcnt(9)
    v_mfma_f32_32x32x16_bf16 v[0:15], a[120:123], v[184:187], v[0:15]
    v_mfma_f32_32x32x16_bf16 v[16:31], a[124:127], v[184:187], v[16:31]
    v_mfma_f32_32x32x16_bf16 v[32:47], a[120:123], v[188:191], v[32:47]
    s_waitcnt vmcnt(8)
    ds_read_b64_tr_b16 a[32:33], v235 offset:0
    ds_read_b64_tr_b16 a[36:37], v236 offset:0
    ds_read_b64_tr_b16 a[34:35], v235 offset:1024
    ds_read_b64_tr_b16 a[38:39], v236 offset:1024
    v_mfma_f32_32x32x16_bf16 v[48:63], a[124:127], v[188:191], v[48:63]
    s_waitcnt vmcnt(7)
    v_cmp_ne_u32 vcc, s47, v243
    s_nop 4
    s_and_b64 s[60:61], vcc, s[82:83]
    s_cbranch_scc1 L_spin26
L_ok25:
    buffer_load_dwordx4 v[96:99], v225, s[24:27], s68 offen offset:0 sc1
    buffer_load_dwordx4 v[100:103], v226, s[24:27], s68 offen offset:0 sc1
    buffer_load_dwordx4 v[104:107], v225, s[24:27], s68 offen offset:1024 sc1
    s_waitcnt vmcnt(9)
    v_cmp_ne_u32 vcc, s47, v252
    v_cmp_ne_u32 s[60:61], s47, v253
    s_nop 4
    s_or_b64 s[60:61], vcc, s[60:61]
    s_cbranch_scc1 L_spin29
L_ok28:
    buffer_load_dwordx4 v[108:111], v226, s[24:27], s68 offen offset:1024 sc1
    buffer_load_dwordx4 v[112:115], v225, s[24:27], s68 offen offset:2048 sc1
    s_waitcnt vmcnt(9)
    ds_read_b64_tr_b16 a[40:41], v235 offset:2048
    ds_read_b64_tr_b16 a[44:45], v236 offset:2048
    ds_read_b64_tr_b16 a[42:43], v235 offset:3072
    ds_read_b64_tr_b16 a[46:47], v236 offset:3072
    buffer_load_dwordx4 v[116:119], v226, s[24:27], s68 offen offset:2048 sc1
    buffer_load_dwordx4 v[120:123], v225, s[24:27], s69 offen offset:0 sc1
    s_waitcnt vmcnt(9)
    ds_read_b64_tr_b16 a[48:49], v235 offset:32768
    ds_read_b64_tr_b16 a[52:53], v236 offset:32768
    ds_read_b64_tr_b16 a[50:51], v235 offset:33792
    ds_read_b64_tr_b16 a[54:55], v236 offset:33792
    buffer_load_dwordx4 v[124:127], v226, s[24:27], s69 offen offset:0 sc1
    buffer_load_dwordx4 v[128:131], v242, s[24:27], s88 offen offset:0 sc1
    buffer_load_dwordx4 v[132:135], v242, s[24:27], s88 offen offset:1024 sc1
    s_waitcnt vmcnt(10)
    ds_read_b64_tr_b16 a[56:57], v235 offset:34816
    ds_read_b64_tr_b16 a[60:61], v236 offset:34816
    ds_read_b64_tr_b16 a[58:59], v235 offset:35840
    ds_read_b64_tr_b16 a[62:63], v236 offset:35840
    buffer_load_dwordx4 v[136:139], v227, s[24:27], s72 offen offset:0 sc1
    buffer_load_dwordx4 v[140:143], v228, s[24:27], s72 offen offset:0 sc1
    buffer_load_dwordx4 a[224:227], v229, s[24:27], s72 offen offset:0 sc1
    buffer_load_dwordx4 v[144:147], v225, s[24:27], s69 offen offset:1024 sc1
    buffer_load_dwordx4 v[148:151], v226, s[24:27], s69 offen offset:1024 sc1
    buffer_load_dwordx4 v[152:155], v227, s[24:27], s72 offen offset:1024 sc1
    buffer_load_dwordx4 v[156:159], v228, s[24:27], s72 offen offset:1024 sc1
    s_waitcnt vmcnt(15)
    v_mfma_f32_32x32x16_bf16 v[0:15], a[128:131], v[96:99], v[0:15]
    v_mfma_f32_32x32x16_bf16 v[16:31], a[132:135], v[96:99], v[16:31]
    buffer_load_dwordx4 a[228:231], v229, s[24:27], s72 offen offset:1024 sc1
    v_mfma_f32_32x32x16_bf16 v[32:47], a[128:131], v[100:103], v[32:47]
    v_mfma_f32_32x32x16_bf16 v[48:63], a[132:135], v[100:103], v[48:63]
    buffer_load_dwordx4 v[64:67], v225, s[24:27], s69 offen offset:2048 sc1
    s_waitcnt vmcnt(15)
    v_mfma_f32_32x32x16_bf16 v[0:15], a[136:139], v[104:107], v[0:15]
    v_mfma_f32_32x32x16_bf16 v[16:31], a[140:143], v[104:107], v[16:31]
    buffer_load_dwordx4 v[68:71], v226, s[24:27], s69 offen offset:2048 sc1
    v_mfma_f32_32x32x16_bf16 v[32:47], a[136:139], v[108:111], v[32:47]
    v_mfma_f32_32x32x16_bf16 v[48:63], a[140:143], v[108:111], v[48:63]
    buffer_load_dwordx4 v[72:75], v227, s[24:27], s73 offen offset:0 sc1
    s_waitcnt vmcnt(15) lgkmcnt(15)
    v_mfma_f32_32x32x16_bf16 v[0:15], a[144:147], v[112:115], v[0:15]
    v_mfma_f32_32x32x16_bf16 v[16:31], a[148:151], v[112:115], v[16:31]
    buffer_load_dwordx4 v[76:79], v228, s[24:27], s73 offen offset:0 sc1
    v_mfma_f32_32x32x16_bf16 v[32:47], a[144:147], v[116:119], v[32:47]
    v_mfma_f32_32x32x16_bf16 v[48:63], a[148:151], v[116:119], v[48:63]
    buffer_load_dwordx4 a[232:235], v229, s[24:27], s73 offen offset:0 sc1
    s_waitcnt vmcnt(15)
    v_mfma_f32_32x32x16_bf16 v[0:15], a[152:155], v[120:123], v[0:15]
    v_mfma_f32_32x32x16_bf16 v[16:31], a[156:159], v[120:123], v[16:31]
    buffer_load_dwordx4 v[80:83], v225, s[24:27], s70 offen offset:0 sc1
    v_mfma_f32_32x32x16_bf16 v[32:47], a[152:155], v[124:127], v[32:47]
    v_mfma_f32_32x32x16_bf16 v[48:63], a[156:159], v[124:127], v[48:63]
    buffer_load_dwordx4 v[84:87], v226, s[24:27], s70 offen offset:0 sc1
    buffer_load_dwordx4 v[88:91], v227, s[24:27], s73 offen offset:1024 sc1
    s_waitcnt vmcnt(16)
    v_add_f32 v128, v128, v129
    v_add_f32 v130, v130, v131
    v_add_f32 v128, v128, v130
    v_mov_b32 v129, v128
    s_nop 1
    v_permlane32_swap_b32 v128, v129
    v_add_f32 v128, v128, v129
    v_min_f32 v128, 0x41f00000, v128
    v_mul_f32 v128, 0x3fb8aa3b, v128
    v_exp_f32 v248, v128
    s_nop 0
    v_add_f32 v128, 1.0, v248
    v_rcp_f32 v250, v128
    v_add_f32 v132, v132, v133
    v_add_f32 v134, v134, v135
    v_add_f32 v132, v132, v134
    v_mov_b32 v133, v132
    s_nop 1
    v_permlane32_swap_b32 v132, v133
    v_add_f32 v132, v132, v133
    v_min_f32 v132, 0x41f00000, v132
    v_mul_f32 v132, 0x3fb8aa3b, v132
    v_exp_f32 v249, v132
    buffer_load_dwordx4 v[92:95], v228, s[24:27], s73 offen offset:1024 sc1
    v_add_f32 v132, 1.0, v249
    v_rcp_f32 v251, v132
    s_waitcnt lgkmcnt(0)
    v_lshrrev_b32 v224, 5, v241
    v_and_b32 v254, 7, v241
    v_xor_b32 v224, v224, v254
    v_lshlrev_b32 v224, 4, v224
    v_and_b32 v255, 31, v241
    v_lshl_add_u32 v224, v255, 8, v224
    v_add_u32 v233, s46, v224
    v_xor_b32 v234, 32, v233
    v_xor_b32 v235, 64, v233
    v_xor_b32 v236, 96, v233
    v_lshrrev_b32 v255, 3, v241
    v_lshlrev_b32 v224, 1, v254
    v_xor_b32 v224, v224, v255
    buffer_load_dwordx4 a[236:239], v229, s[24:27], s73 offen offset:1024 sc1
    v_lshlrev_b32 v224, 4, v224
    v_lshl_add_u32 v224, v255, 8, v224
    s_lshl_b32 s51, s40, 11
    v_add_u32 v237, s51, v224
    v_xor_b32 v238, 16, v237
    v_lshlrev_b32 v224, 10, v255
    v_lshl_add_u32 v239, v254, 4, v224
    s_lshl_b32 s51, s40, 5
    v_lshl_add_u32 v240, v255, 2, s51
    s_waitcnt vmcnt(15)
    v_mfma_f32_32x32x16_bf16 v[192:207], a[224:227], v[136:139], 0
    v_mfma_f32_32x32x16_bf16 v[208:223], a[224:227], v[140:143], 0
    buffer_load_dwordx4 v[160:163], v225, s[24:27], s70 offen offset:1024 sc1
    buffer_load_dwordx4 v[164:167], v226, s[24:27], s70 offen offset:1024 sc1
    s_nop 8
    v_add_f32 v252, 0x358637bd, v200
    v_rcp_f32 v252, v252
    s_nop 0
    v_mul_f32 v252, v252, v248
    v_mul_f32 v192, v192, v252
    v_mul_f32 v193, v193, v252
    v_mul_f32 v194, v194, v252
    v_mul_f32 v195, v195, v252
    v_mul_f32 v196, v196, v252
    v_mul_f32 v197, v197, v252
    v_mul_f32 v198, v198, v252
    v_mul_f32 v199, v199, v252
    v_cvt_pk_bf16_f32 v192, v192, v193
    v_cvt_pk_bf16_f32 v193, v194, v195
    v_cvt_pk_bf16_f32 v194, v196, v197
    v_cvt_pk_bf16_f32 v195, v198, v199
    s_waitcnt vmcnt(15)
    v_mfma_f32_32x32x16_bf16 v[0:15], a[160:163], v[144:147], v[0:15]
    v_add_f32 v253, 0x358637bd, v216
    v_rcp_f32 v253, v253
    s_nop 0
    v_mul_f32 v253, v253, v249
    buffer_load_dwordx4 v[168:171], v227, s[24:27], s74 offen offset:0 sc1
    v_mul_f32 v208, v208, v253
    v_mul_f32 v209, v209, v253
    v_mfma_f32_32x32x16_bf16 v[16:31], a[164:167], v[144:147], v[16:31]
    v_mul_f32 v210, v210, v253
    v_mul_f32 v211, v211, v253
    v_mul_f32 v212, v212, v253
    v_mul_f32 v213, v213, v253
    v_mul_f32 v214, v214, v253
    v_mul_f32 v215, v215, v253
    v_mfma_f32_32x32x16_bf16 v[32:47], a[160:163], v[148:151], v[32:47]
    v_cvt_pk_bf16_f32 v208, v208, v209
    v_cvt_pk_bf16_f32 v209, v210, v211
    v_cvt_pk_bf16_f32 v210, v212, v213
    v_cvt_pk_bf16_f32 v211, v214, v215
    v_mfma_f32_32x32x16_bf16 v[48:63], a[164:167], v[148:151], v[48:63]
    buffer_load_dwordx4 v[172:175], v228, s[24:27], s74 offen offset:0 sc1
    v_mfma_f32_32x32x16_bf16 v[0:15], a[0:3], v[192:195], v[0:15]
    v_mfma_f32_32x32x16_bf16 v[16:31], a[4:7], v[192:195], v[16:31]
    buffer_load_dwordx4 a[240:243], v229, s[24:27], s74 offen offset:0 sc1
    v_mfma_f32_32x32x16_bf16 v[32:47], a[0:3], v[208:211], v[32:47]
    v_mfma_f32_32x32x16_bf16 v[48:63], a[4:7], v[208:211], v[48:63]
    s_waitcnt vmcnt(15)
    v_mfma_f32_32x32x16_bf16 v[192:207], a[228:231], v[152:155], 0
    buffer_load_dwordx4 v[176:179], v225, s[24:27], s70 offen offset:2048 sc1
    v_mfma_f32_32x32x16_bf16 v[208:223], a[228:231], v[156:159], 0
    buffer_load_dwordx4 v[180:183], v226, s[24:27], s70 offen offset:2048 sc1
    s_waitcnt vmcnt(15)
    v_mfma_f32_32x32x16_bf16 v[0:15], a[168:171], v[64:67], v[0:15]
    s_nop 6
    v_add_f32 v252, 0x358637bd, v192
    v_rcp_f32 v252, v252
    s_nop 0
    v_mul_f32 v252, v252, v248
    buffer_load_dwordx4 v[184:187], v227, s[24:27], s74 offen offset:1024 sc1
    v_mul_f32 v200, v200, v252
    v_mul_f32 v201, v201, v252
    v_mfma_f32_32x32x16_bf16 v[16:31], a[172:175], v[64:67], v[16:31]
    v_mul_f32 v202, v202, v252
    v_mul_f32 v203, v203, v252
    v_mul_f32 v204, v204, v252
    v_mul_f32 v205, v205, v252
    v_mul_f32 v206, v206, v252
    v_mul_f32 v207, v207, v252
    v_mfma_f32_32x32x16_bf16 v[32:47], a[168:171], v[68:71], v[32:47]
    v_cvt_pk_bf16_f32 v200, v200, v201
    v_cvt_pk_bf16_f32 v201, v202, v203
    v_cvt_pk_bf16_f32 v202, v204, v205
    v_cvt_pk_bf16_f32 v203, v206, v207
    v_add_f32 v253, 0x358637bd, v208
    buffer_load_dwordx4 v[188:191], v228, s[24:27], s74 offen offset:1024 sc1
    v_rcp_f32 v253, v253
    v_mfma_f32_32x32x16_bf16 v[48:63], a[172:175], v[68:71], v[48:63]
    v_mul_f32 v253, v253, v249
    v_mul_f32 v216, v216, v253
    v_mul_f32 v217, v217, v253
    v_mul_f32 v218, v218, v253
    v_mul_f32 v219, v219, v253
    v_mul_f32 v220, v220, v253
    v_mfma_f32_32x32x16_bf16 v[0:15], a[8:11], v[200:203], v[0:15]
    v_mul_f32 v221, v221, v253
    v_mul_f32 v222, v222, v253
    v_mul_f32 v223, v223, v253
    v_cvt_pk_bf16_f32 v216, v216, v217
    v_cvt_pk_bf16_f32 v217, v218, v219
    buffer_load_dwordx4 a[244:247], v229, s[24:27], s74 offen offset:1024 sc1
    v_cvt_pk_bf16_f32 v218, v220, v221
    v_mfma_f32_32x32x16_bf16 v[16:31], a[12:15], v[200:203], v[16:31]
    v_cvt_pk_bf16_f32 v219, v222, v223
    s_nop 1
    v_mfma_f32_32x32x16_bf16 v[32:47], a[8:11], v[216:219], v[32:47]
    v_mfma_f32_32x32x16_bf16 v[48:63], a[12:15], v[216:219], v[48:63]
    buffer_load_dwordx4 v[128:131], v225, s[24:27], s71 offen offset:0 sc1
    s_waitcnt vmcnt(16)
    v_mfma_f32_32x32x16_bf16 v[192:207], a[232:235], v[72:75], 0
    v_mfma_f32_32x32x16_bf16 v[208:223], a[232:235], v[76:79], 0
    buffer_load_dwordx4 v[132:135], v226, s[24:27], s71 offen offset:0 sc1
    s_waitcnt vmcnt(15)
    v_mfma_f32_32x32x16_bf16 v[0:15], a[176:179], v[80:83], v[0:15]
    s_nop 7
    v_add_f32 v252, 0x358637bd, v200
    v_rcp_f32 v252, v252
    s_nop 0
    v_mul_f32 v252, v252, v248
    buffer_load_dwordx4 v[96:99], v227, s[24:27], s75 offen offset:0 sc1
    v_mul_f32 v192, v192, v252
    v_mul_f32 v193, v193, v252
    v_mfma_f32_32x32x16_bf16 v[16:31], a[180:183], v[80:83], v[16:31]
    v_mul_f32 v194, v194, v252
    v_mul_f32 v195, v195, v252
    v_mul_f32 v196, v196, v252
    v_mul_f32 v197, v197, v252
    v_mul_f32 v198, v198, v252
    v_mul_f32 v199, v199, v252
    v_mfma_f32_32x32x16_bf16 v[32:47], a[176:179], v[84:87], v[32:47]
    v_cvt_pk_bf16_f32 v192, v192, v193
    v_cvt_pk_bf16_f32 v193, v194, v195
    v_cvt_pk_bf16_f32 v194, v196, v197
    v_cvt_pk_bf16_f32 v195, v198, v199
    v_add_f32 v253, 0x358637bd, v216
    buffer_load_dwordx4 v[100:103], v228, s[24:27], s75 offen offset:0 sc1
    v_rcp_f32 v253, v253
    v_mfma_f32_32x32x16_bf16 v[48:63], a[180:183], v[84:87], v[48:63]
    v_mul_f32 v253, v253, v249
    v_mul_f32 v208, v208, v253
    v_mul_f32 v209, v209, v253
    v_mul_f32 v210, v210, v253
    v_mul_f32 v211, v211, v253
    v_mul_f32 v212, v212, v253
    v_mfma_f32_32x32x16_bf16 v[0:15], a[16:19], v[192:195], v[0:15]
    v_mul_f32 v213, v213, v253
    v_mul_f32 v214, v214, v253
    v_mul_f32 v215, v215, v253
    v_cvt_pk_bf16_f32 v208, v208, v209
    v_cvt_pk_bf16_f32 v209, v210, v211
    buffer_load_dwordx4 a[248:251], v229, s[24:27], s75 offen offset:0 sc1
    v_cvt_pk_bf16_f32 v210, v212, v213
    v_mfma_f32_32x32x16_bf16 v[16:31], a[20:23], v[192:195], v[16:31]
    v_cvt_pk_bf16_f32 v211, v214, v215
    s_nop 1
    v_mfma_f32_32x32x16_bf16 v[32:47], a[16:19], v[208:211], v[32:47]
    v_mfma_f32_32x32x16_bf16 v[48:63], a[20:23], v[208:211], v[48:63]
    buffer_load_dwordx4 v[104:107], v225, s[24:27], s71 offen offset:1024 sc1
    s_waitcnt vmcnt(16)
    v_mfma_f32_32x32x16_bf16 v[192:207], a[236:239], v[88:91], 0
    v_mfma_f32_32x32x16_bf16 v[208:223], a[236:239], v[92:95], 0
    buffer_load_dwordx4 v[108:111], v226, s[24:27], s71 offen offset:1024 sc1
    s_waitcnt vmcnt(15)
    v_mfma_f32_32x32x16_bf16 v[0:15], a[184:187], v[160:163], v[0:15]
    s_nop 7
    v_add_f32 v252, 0x358637bd, v192
    v_rcp_f32 v252, v252
    s_nop 0
    v_mul_f32 v252, v252, v248
    buffer_load_dwordx4 v[112:115], v227, s[24:27], s75 offen offset:1024 sc1
    v_mul_f32 v200, v200, v252
    v_mul_f32 v201, v201, v252
    v_mfma_f32_32x32x16_bf16 v[16:31], a[188:191], v[160:163], v[16:31]
    v_mul_f32 v202, v202, v252
    v_mul_f32 v203, v203, v252
    v_mul_f32 v204, v204, v252
    v_mul_f32 v205, v205, v252
    v_mul_f32 v206, v206, v252
    v_mul_f32 v207, v207, v252
    v_mfma_f32_32x32x16_bf16 v[32:47], a[184:187], v[164:167], v[32:47]
    v_cvt_pk_bf16_f32 v200, v200, v201
    v_cvt_pk_bf16_f32 v201, v202, v203
    v_cvt_pk_bf16_f32 v202, v204, v205
    v_cvt_pk_bf16_f32 v203, v206, v207
    v_add_f32 v253, 0x358637bd, v208
    buffer_load_dwordx4 v[116:119], v228, s[24:27], s75 offen offset:1024 sc1
    v_rcp_f32 v253, v253
    v_mfma_f32_32x32x16_bf16 v[48:63], a[188:191], v[164:167], v[48:63]
    v_mul_f32 v253, v253, v249
    v_mul_f32 v216, v216, v253
    v_mul_f32 v217, v217, v253
    v_mul_f32 v218, v218, v253
    v_mul_f32 v219, v219, v253
    v_mul_f32 v220, v220, v253
    v_mfma_f32_32x32x16_bf16 v[0:15], a[24:27], v[200:203], v[0:15]
    v_mul_f32 v221, v221, v253
    v_mul_f32 v222, v222, v253
    v_mul_f32 v223, v223, v253
    v_cvt_pk_bf16_f32 v216, v216, v217
    v_cvt_pk_bf16_f32 v217, v218, v219
    buffer_load_dwordx4 a[252:255], v229, s[24:27], s75 offen offset:1024 sc1
    v_cvt_pk_bf16_f32 v218, v220, v221
    v_mfma_f32_32x32x16_bf16 v[16:31], a[28:31], v[200:203], v[16:31]
    v_cvt_pk_bf16_f32 v219, v222, v223
    s_nop 1
    v_mfma_f32_32x32x16_bf16 v[32:47], a[24:27], v[216:219], v[32:47]
    v_mfma_f32_32x32x16_bf16 v[48:63], a[28:31], v[216:219], v[48:63]
    buffer_load_dwordx4 v[120:123], v225, s[24:27], s71 offen offset:2048 sc1
    s_waitcnt vmcnt(16)
    v_mfma_f32_32x32x16_bf16 v[192:207], a[240:243], v[168:171], 0
    v_mfma_f32_32x32x16_bf16 v[208:223], a[240:243], v[172:175], 0
    buffer_load_dwordx4 v[124:127], v226, s[24:27], s71 offen offset:2048 sc1
    s_waitcnt vmcnt(15)
    v_mfma_f32_32x32x16_bf16 v[0:15], a[192:195], v[176:179], v[0:15]
    s_nop 7
    v_add_f32 v252, 0x358637bd, v200
    v_rcp_f32 v252, v252
    s_nop 0
    v_mul_f32 v252, v252, v248
    v_mul_f32 v192, v192, v252
    v_mul_f32 v193, v193, v252
    v_mfma_f32_32x32x16_bf16 v[16:31], a[196:199], v[176:179], v[16:31]
    v_mul_f32 v194, v194, v252
    v_mul_f32 v195, v195, v252
    v_mul_f32 v196, v196, v252
    v_mul_f32 v197, v197, v252
    v_mul_f32 v198, v198, v252
    v_mul_f32 v199, v199, v252
    v_mfma_f32_32x32x16_bf16 v[32:47], a[192:195], v[180:183], v[32:47]
    v_cvt_pk_bf16_f32 v192, v192, v193
    v_cvt_pk_bf16_f32 v193, v194, v195
    v_cvt_pk_bf16_f32 v194, v196, v197
    v_cvt_pk_bf16_f32 v195, v198, v199
    v_add_f32 v253, 0x358637bd, v216
    v_rcp_f32 v253, v253
    v_mfma_f32_32x32x16_bf16 v[48:63], a[196:199], v[180:183], v[48:63]
    v_mul_f32 v253, v253, v249
    v_mul_f32 v208, v208, v253
    v_mul_f32 v209, v209, v253
    v_mul_f32 v210, v210, v253
    v_mul_f32 v211, v211, v253
    v_mul_f32 v212, v212, v253
    v_mfma_f32_32x32x16_bf16 v[0:15], a[32:35], v[192:195], v[0:15]
    v_mul_f32 v213, v213, v253
    v_mul_f32 v214, v214, v253
    v_mul_f32 v215, v215, v253
    v_cvt_pk_bf16_f32 v208, v208, v209
    v_cvt_pk_bf16_f32 v209, v210, v211
    v_cvt_pk_bf16_f32 v210, v212, v213
    v_mfma_f32_32x32x16_bf16 v[16:31], a[36:39], v[192:195], v[16:31]
    v_cvt_pk_bf16_f32 v211, v214, v215
    s_nop 1
    v_mfma_f32_32x32x16_bf16 v[32:47], a[32:35], v[208:211], v[32:47]
    v_mfma_f32_32x32x16_bf16 v[48:63], a[36:39], v[208:211], v[48:63]
    s_waitcnt vmcnt(12)
    v_mfma_f32_32x32x16_bf16 v[192:207], a[244:247], v[184:187], 0
    v_mfma_f32_32x32x16_bf16 v[208:223], a[244:247], v[188:191], 0
    s_waitcnt vmcnt(10)
    v_mfma_f32_32x32x16_bf16 v[0:15], a[200:203], v[128:131], v[0:15]
    s_nop 8
    v_add_f32 v252, 0x358637bd, v192
    v_rcp_f32 v252, v252
    s_nop 0
    v_mul_f32 v252, v252, v248
    v_mul_f32 v200, v200, v252
    v_mul_f32 v201, v201, v252
    v_mfma_f32_32x32x16_bf16 v[16:31], a[204:207], v[128:131], v[16:31]
    v_mul_f32 v202, v202, v252
    v_mul_f32 v203, v203, v252
    v_mul_f32 v204, v204, v252
    v_mul_f32 v205, v205, v252
    v_mul_f32 v206, v206, v252
    v_mul_f32 v207, v207, v252
    v_mfma_f32_32x32x16_bf16 v[32:47], a[200:203], v[132:135], v[32:47]
    v_cvt_pk_bf16_f32 v200, v200, v201
    v_cvt_pk_bf16_f32 v201, v202, v203
    v_cvt_pk_bf16_f32 v202, v204, v205
    v_cvt_pk_bf16_f32 v203, v206, v207
    v_add_f32 v253, 0x358637bd, v208
    v_rcp_f32 v253, v253
    v_mfma_f32_32x32x16_bf16 v[48:63], a[204:207], v[132:135], v[48:63]
    v_mul_f32 v253, v253, v249
    v_mul_f32 v216, v216, v253
    v_mul_f32 v217, v217, v253
    v_mul_f32 v218, v218, v253
    v_mul_f32 v219, v219, v253
    v_mul_f32 v220, v220, v253
    v_mfma_f32_32x32x16_bf16 v[0:15], a[40:43], v[200:203], v[0:15]
    v_mul_f32 v221, v221, v253
    v_mul_f32 v222, v222, v253
    v_mul_f32 v223, v223, v253
    v_cvt_pk_bf16_f32 v216, v216, v217
    v_cvt_pk_bf16_f32 v217, v218, v219
    v_cvt_pk_bf16_f32 v218, v220, v221
    v_mfma_f32_32x32x16_bf16 v[16:31], a[44:47], v[200:203], v[16:31]
    v_cvt_pk_bf16_f32 v219, v222, v223
    s_nop 1
    v_mfma_f32_32x32x16_bf16 v[32:47], a[40:43], v[216:219], v[32:47]
    v_mfma_f32_32x32x16_bf16 v[48:63], a[44:47], v[216:219], v[48:63]
    s_waitcnt vmcnt(7)
    v_mfma_f32_32x32x16_bf16 v[192:207], a[248:251], v[96:99], 0
    v_mfma_f32_32x32x16_bf16 v[208:223], a[248:251], v[100:103], 0
    s_waitcnt vmcnt(5)
    v_mfma_f32_32x32x16_bf16 v[0:15], a[208:211], v[104:107], v[0:15]
    s_nop 8
    v_add_f32 v252, 0x358637bd, v200
    v_rcp_f32 v252, v252
    s_nop 0
    v_mul_f32 v252, v252, v248
    v_mul_f32 v192, v192, v252
    v_mul_f32 v193, v193, v252
    v_mfma_f32_32x32x16_bf16 v[16:31], a[212:215], v[104:107], v[16:31]
    v_mul_f32 v194, v194, v252
    v_mul_f32 v195, v195, v252
    v_mul_f32 v196, v196, v252
    v_mul_f32 v197, v197, v252
    v_mul_f32 v198, v198, v252
    v_mul_f32 v199, v199, v252
    v_mfma_f32_32x32x16_bf16 v[32:47], a[208:211], v[108:111], v[32:47]
    v_cvt_pk_bf16_f32 v192, v192, v193
    v_cvt_pk_bf16_f32 v193, v194, v195
    v_cvt_pk_bf16_f32 v194, v196, v197
    v_cvt_pk_bf16_f32 v195, v198, v199
    v_add_f32 v253, 0x358637bd, v216
    v_rcp_f32 v253, v253
    v_mfma_f32_32x32x16_bf16 v[48:63], a[212:215], v[108:111], v[48:63]
    v_mul_f32 v253, v253, v249
    v_mul_f32 v208, v208, v253
    v_mul_f32 v209, v209, v253
    v_mul_f32 v210, v210, v253
    v_mul_f32 v211, v211, v253
    v_mul_f32 v212, v212, v253
    v_mfma_f32_32x32x16_bf16 v[0:15], a[48:51], v[192:195], v[0:15]
    v_mul_f32 v213, v213, v253
    v_mul_f32 v214, v214, v253
    v_mul_f32 v215, v215, v253
    v_cvt_pk_bf16_f32 v208, v208, v209
    v_cvt_pk_bf16_f32 v209, v210, v211
    v_cvt_pk_bf16_f32 v210, v212, v213
    v_mfma_f32_32x32x16_bf16 v[16:31], a[52:55], v[192:195], v[16:31]
    v_cvt_pk_bf16_f32 v211, v214, v215
    s_nop 1
    v_mfma_f32_32x32x16_bf16 v[32:47], a[48:51], v[208:211], v[32:47]
    v_mfma_f32_32x32x16_bf16 v[48:63], a[52:55], v[208:211], v[48:63]
    s_waitcnt vmcnt(2)
    v_mfma_f32_32x32x16_bf16 v[192:207], a[252:255], v[112:115], 0
    v_mfma_f32_32x32x16_bf16 v[208:223], a[252:255], v[116:119], 0
    s_waitcnt vmcnt(0)
    v_mfma_f32_32x32x16_bf16 v[0:15], a[216:219], v[120:123], v[0:15]
    s_nop 8
    v_add_f32 v252, 0x358637bd, v192
    v_rcp_f32 v252, v252
    s_nop 0
    v_mul_f32 v252, v252, v248
    v_mul_f32 v200, v200, v252
    v_mul_f32 v201, v201, v252
    v_mfma_f32_32x32x16_bf16 v[16:31], a[220:223], v[120:123], v[16:31]
    v_mul_f32 v202, v202, v252
    v_mul_f32 v203, v203, v252
    v_mul_f32 v204, v204, v252
    v_mul_f32 v205, v205, v252
    v_mul_f32 v206, v206, v252
    v_mul_f32 v207, v207, v252
    v_mfma_f32_32x32x16_bf16 v[32:47], a[216:219], v[124:127], v[32:47]
    v_cvt_pk_bf16_f32 v200, v200, v201
    v_cvt_pk_bf16_f32 v201, v202, v203
    v_cvt_pk_bf16_f32 v202, v204, v205
    v_cvt_pk_bf16_f32 v203, v206, v207
    v_add_f32 v253, 0x358637bd, v208
    v_rcp_f32 v253, v253
    v_mfma_f32_32x32x16_bf16 v[48:63], a[220:223], v[124:127], v[48:63]
    v_mul_f32 v253, v253, v249
    v_mul_f32 v216, v216, v253
    v_mul_f32 v217, v217, v253
    v_mul_f32 v218, v218, v253
    v_mul_f32 v219, v219, v253
    v_mul_f32 v220, v220, v253
    v_mfma_f32_32x32x16_bf16 v[0:15], a[56:59], v[200:203], v[0:15]
    v_mul_f32 v221, v221, v253
    v_mul_f32 v222, v222, v253
    v_mul_f32 v223, v223, v253
    v_cvt_pk_bf16_f32 v216, v216, v217
    v_cvt_pk_bf16_f32 v217, v218, v219
    v_cvt_pk_bf16_f32 v218, v220, v221
    v_mfma_f32_32x32x16_bf16 v[16:31], a[60:63], v[200:203], v[16:31]
    v_cvt_pk_bf16_f32 v219, v222, v223
    s_nop 1
    v_mfma_f32_32x32x16_bf16 v[32:47], a[56:59], v[216:219], v[32:47]
    v_mfma_f32_32x32x16_bf16 v[48:63], a[60:63], v[216:219], v[48:63]
    ds_bpermute_b32 v248, v240, v250
    ds_bpermute_b32 v249, v240, v251
    ds_write_b128 v233, v[0:3] offset:0
    ds_write_b128 v234, v[4:7] offset:0
    ds_write_b128 v235, v[8:11] offset:0
    ds_write_b128 v236, v[12:15] offset:0
    s_nop 0
    ds_write_b128 v233, v[16:19] offset:128
    ds_write_b128 v234, v[20:23] offset:128
    ds_write_b128 v235, v[24:27] offset:128
    ds_write_b128 v236, v[28:31] offset:128
    ds_write_b128 v233, v[32:35] offset:32768
    ds_write_b128 v234, v[36:39] offset:32768
    ds_write_b128 v235, v[40:43] offset:32768
    ds_write_b128 v236, v[44:47] offset:32768
    ds_write_b128 v233, v[48:51] offset:32896
    ds_write_b128 v234, v[52:55] offset:32896
    ds_write_b128 v235, v[56:59] offset:32896
    ds_write_b128 v236, v[60:63] offset:32896
    s_waitcnt lgkmcnt(0)
    s_barrier
    ds_read_b128 v[0:3], v237 offset:0
    ds_read_b128 v[4:7], v238 offset:0
    ds_read_b128 v[8:11], v237 offset:8192
    ds_read_b128 v[12:15], v238 offset:8192
    ds_read_b128 v[16:19], v237 offset:16384
    ds_read_b128 v[20:23], v238 offset:16384
    ds_read_b128 v[24:27], v237 offset:24576
    ds_read_b128 v[28:31], v238 offset:24576
    ds_read_b128 v[32:35], v237 offset:32768
    ds_read_b128 v[36:39], v238 offset:32768
    ds_read_b128 v[40:43], v237 offset:40960
    ds_read_b128 v[44:47], v238 offset:40960
    ds_read_b128 v[48:51], v237 offset:49152
    ds_read_b128 v[52:55], v238 offset:49152
    ds_read_b128 v[56:59], v237 offset:57344
    ds_read_b128 v[60:63], v238 offset:57344
    s_waitcnt lgkmcnt(12)
    v_pk_add_f32 v[0:1], v[0:1], v[8:9]
    v_pk_add_f32 v[2:3], v[2:3], v[10:11]
    v_pk_add_f32 v[4:5], v[4:5], v[12:13]
    v_pk_add_f32 v[6:7], v[6:7], v[14:15]
    s_waitcnt lgkmcnt(8)
    v_pk_add_f32 v[16:17], v[16:17], v[24:25]
    v_pk_add_f32 v[18:19], v[18:19], v[26:27]
    v_pk_add_f32 v[20:21], v[20:21], v[28:29]
    v_pk_add_f32 v[22:23], v[22:23], v[30:31]
    v_pk_add_f32 v[0:1], v[0:1], v[16:17]
    v_pk_add_f32 v[2:3], v[2:3], v[18:19]
    v_pk_add_f32 v[4:5], v[4:5], v[20:21]
    v_pk_add_f32 v[6:7], v[6:7], v[22:23]
    v_mul_f32 v0, v0, v248
    v_mul_f32 v1, v1, v248
    v_mul_f32 v2, v2, v248
    v_mul_f32 v3, v3, v248
    v_mul_f32 v4, v4, v248
    v_mul_f32 v5, v5, v248
    v_mul_f32 v6, v6, v248
    v_mul_f32 v7, v7, v248
    v_cvt_pk_bf16_f32 v0, v0, v1
    v_cvt_pk_bf16_f32 v1, v2, v3
    v_cvt_pk_bf16_f32 v2, v4, v5
    v_cvt_pk_bf16_f32 v3, v6, v7
    buffer_store_dwordx4 v[0:3], v239, s[28:31], s96 offen
    s_waitcnt lgkmcnt(4)
    v_pk_add_f32 v[32:33], v[32:33], v[40:41]
    v_pk_add_f32 v[34:35], v[34:35], v[42:43]
    v_pk_add_f32 v[36:37], v[36:37], v[44:45]
    v_pk_add_f32 v[38:39], v[38:39], v[46:47]
    s_waitcnt lgkmcnt(0)
    v_pk_add_f32 v[48:49], v[48:49], v[56:57]
    v_pk_add_f32 v[50:51], v[50:51], v[58:59]
    v_pk_add_f32 v[52:53], v[52:53], v[60:61]
    v_pk_add_f32 v[54:55], v[54:55], v[62:63]
    v_pk_add_f32 v[32:33], v[32:33], v[48:49]
    v_pk_add_f32 v[34:35], v[34:35], v[50:51]
    v_pk_add_f32 v[36:37], v[36:37], v[52:53]
    v_pk_add_f32 v[38:39], v[38:39], v[54:55]
    v_mul_f32 v32, v32, v249
    v_mul_f32 v33, v33, v249
    v_mul_f32 v34, v34, v249
    v_mul_f32 v35, v35, v249
    v_mul_f32 v36, v36, v249
    v_mul_f32 v37, v37, v249
    v_mul_f32 v38, v38, v249
    v_mul_f32 v39, v39, v249
    v_cvt_pk_bf16_f32 v32, v32, v33
    v_cvt_pk_bf16_f32 v33, v34, v35
    v_cvt_pk_bf16_f32 v34, v36, v37
    v_cvt_pk_bf16_f32 v35, v38, v39
    buffer_store_dwordx4 v[32:35], v239, s[28:31], s97 offen
    s_endpgm
L_spin2:
    s_mov_b32 s53, 200000
L_spinl3:
    buffer_load_dword v243, off, s[36:39], 0 sc1
    s_waitcnt vmcnt(0)
    v_readfirstlane_b32 s47, v243
    s_cmp_eq_u32 s47, 0
    s_cbranch_scc0 L_ok1
    s_sub_u32 s53, s53, 1
    s_cmp_lg_u32 s53, 0
    s_cbranch_scc1 L_spinl3
    s_branch L_ok1
L_spin5:
    s_waitcnt vmcnt(0)
    buffer_store_dword v230, v245, s[24:27], 0 offen offset:32 sc1
    s_mov_b32 s53, 200000
L_spinl6:
    buffer_load_dword v243, v231, s[24:27], s89 offen sc1
    s_waitcnt vmcnt(0)
    v_cmp_ne_u32 vcc, s47, v243
    s_nop 4
    s_and_b64 s[60:61], vcc, s[76:77]
    s_cbranch_scc0 L_ok4
    s_sub_u32 s53, s53, 1
    s_cmp_lg_u32 s53, 0
    s_cbranch_scc1 L_spinl6
    s_branch L_ok4
L_spin8:
    s_mov_b32 s53, 200000
L_spinl9:
    buffer_load_dword v243, v231, s[24:27], s89 offen sc1
    s_waitcnt vmcnt(0)
    v_cmp_ne_u32 vcc, s47, v243
    s_nop 4
    s_and_b64 s[60:61], vcc, s[82:83]
    s_cbranch_scc0 L_ok7
    s_sub_u32 s53, s53, 1
    s_cmp_lg_u32 s53, 0
    s_cbranch_scc1 L_spinl9
    s_branch L_ok7
L_spin11:
    s_mov_b32 s53, 200000
L_spinl12:
    buffer_load_dwordx2 v[252:253], v232, s[24:27], s90 offen sc1
    s_waitcnt vmcnt(0)
    v_cmp_ne_u32 vcc, s47, v252
    v_cmp_ne_u32 s[60:61], s47, v253
    s_nop 4
    s_or_b64 s[60:61], vcc, s[60:61]
    s_cbranch_scc0 L_ok10
    s_sub_u32 s53, s53, 1
    s_cmp_lg_u32 s53, 0
    s_cbranch_scc1 L_spinl12
    s_branch L_ok10
L_spin14:
    s_mov_b32 s53, 200000
L_spinl15:
    buffer_load_dword v243, off, s[36:39], 0 sc1
    s_waitcnt vmcnt(0)
    v_readfirstlane_b32 s47, v243
    s_cmp_eq_u32 s47, 0
    s_cbranch_scc0 L_ok13
    s_sub_u32 s53, s53, 1
    s_cmp_lg_u32 s53, 0
    s_cbranch_scc1 L_spinl15
    s_branch L_ok13
L_spin20:
    s_waitcnt vmcnt(0)
    buffer_store_dword v230, v245, s[24:27], 0 offen sc1
    s_mov_b32 s53, 200000
L_spinl21:
    buffer_load_dwordx4 v[160:163], v212, s[24:27], s93 offen offset:0 sc1
    buffer_load_dwordx4 v[164:167], v212, s[24:27], s93 offen offset:1024 sc1
    buffer_load_dwordx4 v[168:171], v212, s[24:27], s92 offen offset:0 sc1
    buffer_load_dwordx4 v[172:175], v212, s[24:27], s92 offen offset:1024 sc1
    s_waitcnt vmcnt(0)
    v_min3_u32 v176, v161, v163, v165
    v_min3_u32 v176, v176, v167, v169
    v_min3_u32 v176, v176, v171, v173
    v_min_u32 v176, v176, v175
    v_max3_u32 v177, v161, v163, v165
    v_max3_u32 v177, v177, v167, v169
    v_max3_u32 v177, v177, v171, v173
    v_max_u32 v177, v177, v175
    v_cmp_ne_u32 vcc, s47, v176
    v_cmp_ne_u32 s[60:61], s47, v177
    s_nop 4
    s_or_b64 s[60:61], vcc, s[60:61]
    s_cbranch_scc0 L_ok19
    s_sub_u32 s53, s53, 1
    s_cmp_lg_u32 s53, 0
    s_cbranch_scc1 L_spinl21
    s_branch L_ok19
L_spin23:
    s_mov_b32 s53, 200000
L_spinl24:
    buffer_load_dword v243, v231, s[24:27], s89 offen sc1
    s_waitcnt vmcnt(0)
    v_cmp_ne_u32 vcc, s47, v243
    s_nop 4
    s_and_b64 s[60:61], vcc, s[76:77]
    s_cbranch_scc0 L_ok22
    s_sub_u32 s53, s53, 1
    s_cmp_lg_u32 s53, 0
    s_cbranch_scc1 L_spinl24
    s_branch L_ok22
L_spin26:
    s_mov_b32 s53, 200000
L_spinl27:
    buffer_load_dword v243, v231, s[24:27], s89 offen sc1
    s_waitcnt vmcnt(0)
    v_cmp_ne_u32 vcc, s47, v243
    s_nop 4
    s_and_b64 s[60:61], vcc, s[82:83]
    s_cbranch_scc0 L_ok25
    s_sub_u32 s53, s53, 1
    s_cmp_lg_u32 s53, 0
    s_cbranch_scc1 L_spinl27
    s_branch L_ok25
L_spin29:
    s_mov_b32 s53, 200000
L_spinl30:
    buffer_load_dwordx2 v[252:253], v232, s[24:27], s90 offen sc1
    s_waitcnt vmcnt(0)
    v_cmp_ne_u32 vcc, s47, v252
    v_cmp_ne_u32 s[60:61], s47, v253
    s_nop 4
    s_or_b64 s[60:61], vcc, s[60:61]
    s_cbranch_scc0 L_ok28
    s_sub_u32 s53, s53, 1
    s_cmp_lg_u32 s53, 0
    s_cbranch_scc1 L_spinl30
    s_branch L_ok28
L_end:
    s_endpgm
.section .rodata,"a"
.p2align 6
.amdhsa_kernel gated_mix__linear_attn_block__dense_activation_silu__prompt_kernel
  .amdhsa_next_free_vgpr 512
  .amdhsa_next_free_sgpr 102
  .amdhsa_accum_offset 256
  .amdhsa_group_segment_fixed_size 0
  .amdhsa_kernarg_size 80
  .amdhsa_user_sgpr_count 2
  .amdhsa_user_sgpr_kernarg_segment_ptr 1
  .amdhsa_system_sgpr_workgroup_id_x 1
.end_amdhsa_kernel
```
